```python
import torch

def _softmax(x, axis=-1):
    return torch.softmax(x, dim=axis)
def _gelu(x):
    return torch.nn.functional.gelu(x, approximate="tanh")
def _silu(x):
    return torch.nn.functional.silu(x)
def _sigmoid(x):
    return torch.sigmoid(x)
def _layernorm(x, axis=-1, eps=1e-5):
    m = x.mean(dim=axis, keepdim=True)
    v = x.var(dim=axis, keepdim=True, unbiased=False)
    return (x - m) / torch.sqrt(v + eps)
def _scatter_add(tgt, idx, src, axis=0):
    return tgt.clone().index_add_(axis, idx, src)
def _segment_sum(src, seg, n):
    out = torch.zeros((n,) + src.shape[1:], dtype=src.dtype)
    return out.index_add_(0, seg, src)
def _pad(x, pw):
    flat = tuple(v for pair in reversed(pw) for v in pair)
    return torch.nn.functional.pad(x, flat)

kernel_name = 'parallel_sum__mha_block_cached__dense_activation_gelu__decode'

def setup_inputs():

    _w = (lambda a: (lambda t: t.to(torch.bfloat16) if t.is_floating_point() else t)(torch.as_tensor(a)))
    def _A_setup():
        B, Sq, D = 8, 1, 512
        H, Sk, Dh = 32, 4096, 128
        return {
            "x": _w((lambda *s: torch.randn(*s, dtype=torch.bfloat16) * 0.05)(B, Sq, D)),
            "k_cache": _w((lambda *s: torch.randn(*s, dtype=torch.bfloat16) * 3.2)(B, H, Sk, Dh)),
            "v_cache": _w((lambda *s: torch.randn(*s, dtype=torch.bfloat16) * 0.8)(B, H, Sk, Dh)),
            "wq": _w((lambda *s: torch.randn(*s, dtype=torch.bfloat16) * 3.2)(D, H * Dh) * (D ** -0.5)),
            "wo": _w((lambda *s: torch.randn(*s, dtype=torch.bfloat16) * 0.8)(H * Dh, D) * ((H * Dh) ** -0.5)),
        }
    _A_in = _A_setup()

    def _B_setup():
        B, S, D, F = 8, 1, 512, 1792
        return {
            "x": _w((lambda *s: torch.randn(*s, dtype=torch.bfloat16) * 0.05)(B, S, D)),
            "w1": _w((lambda *s: torch.randn(*s, dtype=torch.bfloat16) * 3.2)(D, F) * (D ** -0.5)),
            "b1": _w((lambda *s: torch.randn(*s, dtype=torch.bfloat16) * 3.2)(F) * 0.01),
            "w2": _w((lambda *s: torch.randn(*s, dtype=torch.bfloat16) * 0.4)(F, D) * (F ** -0.5)),
            "b2": _w((lambda *s: torch.randn(*s, dtype=torch.bfloat16) * 0.4)(D) * 0.01),
        }
    _B_in = _B_setup()

    return {
        "A_x": _A_in["x"],
        "A_k_cache": _A_in["k_cache"],
        "A_v_cache": _A_in["v_cache"],
        "A_wq": _A_in["wq"],
        "A_wo": _A_in["wo"],
        "B_x": _B_in["x"],
        "B_w1": _B_in["w1"],
        "B_b1": _B_in["b1"],
        "B_w2": _B_in["w2"],
        "B_b2": _B_in["b2"],
    }

def reference(A_x, A_k_cache, A_v_cache, A_wq, A_wo, B_x, B_w1, B_b1, B_w2, B_b2):
    def _A_ref(x, k_cache, v_cache, wq, wo):
        B, Sq, D = x.shape
        H, Dh = 32, 128
        q = (lambda x, *d: x.permute(*d))((x @ wq).reshape(B, Sq, H, Dh), 0, 2, 1, 3)
        scores = torch.einsum("bhqd,bhkd->bhqk", q, k_cache) * (Dh ** -0.5)
        p = _softmax(scores, axis=-1)
        o = torch.einsum("bhqk,bhkd->bhqd", p, v_cache)
        return (lambda x, *d: x.permute(*d))(o, 0, 2, 1, 3).reshape(B, Sq, H * Dh) @ wo

    def _B_ref(x, w1, b1, w2, b2):
        h = torch.einsum("bsd,df->bsf", x, w1) + b1
        h = _gelu(h)
        return torch.einsum("bsf,fd->bsd", h, w2) + b2

    x = A_x
    xn = _layernorm(x, axis=-1)
    return x + _A_ref(xn, A_k_cache, A_v_cache, A_wq, A_wo) + _B_ref(xn, B_w1, B_b1, B_w2, B_b2)
```

```asm
; @launch grid=(256,1,1) block=(512,1,1) lds=22528
.amdgcn_target "amdgcn-amd-amdhsa--gfx950"
.text
.globl parallel_sum__mha_block_cached__dense_activation_gelu__decode_kernel
.p2align 8
.type parallel_sum__mha_block_cached__dense_activation_gelu__decode_kernel,@function
parallel_sum__mha_block_cached__dense_activation_gelu__decode_kernel:
  s_load_dwordx8 s[16:23], s[0:1], 0
  v_lshrrev_b32 v2, 6, v0
  s_cmp_ge_u32 s2, 256
  s_cbranch_scc1 L_end
  v_readfirstlane_b32 s3, v2
  v_and_b32 v1, 63, v0
  v_and_b32 v3, 15, v0
  s_cmp_ge_u32 s3, 4
  s_cbranch_scc1 L_helper
  v_and_b32 v60, 31, v0
  v_lshlrev_b32 v60, 4, v60
  v_lshrrev_b32 v56, 5, v1
  v_lshl_add_u32 v60, v56, 15, v60
  v_lshl_add_u32 v60, v2, 12, v60
  s_lshl_b32 s58, s2, 20
  s_mov_b32 s46, 0x100000
  s_mov_b32 s47, 0x20000
  s_mov_b32 s52, 0
  s_waitcnt lgkmcnt(0)
  s_add_u32 s44, s18, s58
  s_addc_u32 s45, s19, 0
  buffer_load_dwordx4 v[64:67], v60, s[44:47], s52 offen offset:0 nt
  buffer_load_dwordx4 v[68:71], v60, s[44:47], s52 offen offset:512 nt
  buffer_load_dwordx4 v[72:75], v60, s[44:47], s52 offen offset:1024 nt
  buffer_load_dwordx4 v[76:79], v60, s[44:47], s52 offen offset:1536 nt
  buffer_load_dwordx4 v[80:83], v60, s[44:47], s52 offen offset:2048 nt
  s_branch L_stream
L_helper:
  s_sub_u32 s6, s3, 4
  s_lshr_b32 s4, s2, 5
  s_and_b32 s5, s2, 31
  v_lshrrev_b32 v2, 4, v1
  s_lshl_b32 s84, s4, 10
  v_lshlrev_b32 v30, 4, v1
  s_lshl_b32 s86, s6, 7
  v_lshl_add_u32 v35, v2, 2, s86
  v_lshrrev_b32 v34, 2, v3
  v_lshl_add_u32 v34, v34, 4, v35
  v_and_b32 v26, 3, v3
  v_add_lshl_u32 v31, v34, v26, 1
  v_lshlrev_b32 v32, 13, v35
  v_lshl_add_u32 v32, v3, 4, v32
  s_lshl_b32 s87, s5, 8
  v_add_u32 v32, s87, v32
  s_mov_b32 s46, 8192
  s_mov_b32 s47, 0x20000
  s_mov_b32 s50, 4194304
  s_mov_b32 s51, 0x20000
  s_waitcnt lgkmcnt(0)
  s_mov_b64 s[44:45], s[16:17]
  s_mov_b64 s[48:49], s[22:23]
  buffer_load_dwordx4 v[36:39], v30, s[44:47], s84 offen
  buffer_load_ushort v24, v31, s[44:47], s84 offen
  buffer_load_ushort v25, v31, s[44:47], s84 offen offset:128
  s_mov_b32 s88, 0
  buffer_load_dwordx4 v[192:195], v32, s[48:51], s88 offen nt
  s_mov_b32 s88, 8192
  buffer_load_dwordx4 v[196:199], v32, s[48:51], s88 offen nt
  s_mov_b32 s88, 16384
  buffer_load_dwordx4 v[200:203], v32, s[48:51], s88 offen nt
  s_mov_b32 s88, 24576
  buffer_load_dwordx4 v[204:207], v32, s[48:51], s88 offen nt
  s_branch L_helper2
L_stream:
  s_load_dwordx8 s[24:31], s[0:1], 32
  s_load_dwordx8 s[32:39], s[0:1], 64
  s_load_dwordx2 s[40:41], s[0:1], 96
  s_setprio 2
  v_lshrrev_b32 v2, 4, v1
  s_add_u32 s48, s20, s58
  s_addc_u32 s49, s21, 0
  s_mov_b32 s50, 0x100000
  s_mov_b32 s51, 0x20000
  s_mov_b32 s54, 0xcccccccc
  s_mov_b32 s55, 0xcccccccc
  s_mov_b32 s56, 0xaaaaaaaa
  s_mov_b32 s57, 0xaaaaaaaa
  v_lshlrev_b32 v61, 5, v3
  v_and_b32 v26, 1, v3
  v_mov_b32 v27, 0xffff
  v_mov_b32 v28, 0xffff0000
  v_cmp_eq_u32 vcc, 1, v26
  v_lshrrev_b32 v29, 1, v3
  s_nop 0
  v_cndmask_b32 v26, v27, v28, vcc
  v_cmp_eq_u32 vcc, 0, v29
  s_nop 1
  v_cndmask_b32 v8, 0, v26, vcc
  v_cmp_eq_u32 vcc, 1, v29
  s_nop 1
  v_cndmask_b32 v9, 0, v26, vcc
  v_cmp_eq_u32 vcc, 2, v29
  s_nop 1
  v_cndmask_b32 v10, 0, v26, vcc
  v_cmp_eq_u32 vcc, 3, v29
  s_nop 1
  v_cndmask_b32 v11, 0, v26, vcc
  s_cmp_eq_u32 s3, 0
  s_cselect_b32 s72, -1, 0
  s_mov_b32 s66, 0
  s_mov_b32 s63, 2
  s_mov_b32 s84, 1
  s_mov_b64 vcc, 1
  s_xor_b32 s73, s2, 29
  s_or_b32 s73, s73, s3
  s_waitcnt lgkmcnt(0)
  s_add_u32 s64, s40, 1048576
  s_addc_u32 s65, s41, 0
  s_cmp_lg_u32 s73, 0
  s_cbranch_scc1 L_noz
  s_mov_b64 s[76:77], s[64:65]
  s_mov_b32 s78, 139264
  s_mov_b32 s79, 0x20000
  v_mov_b32 v24, 0
  v_mov_b32 v25, 0
  v_mov_b32 v26, 0
  v_mov_b32 v27, 0
  v_lshrrev_b32 v28, 3, v1
  v_mul_u32_u24 v28, 4352, v28
  v_and_b32 v29, 7, v1
  v_lshl_add_u32 v28, v29, 4, v28
  s_mov_b32 s74, 0
  buffer_store_dwordx4 v[24:27], v28, s[76:79], s74 offen sc1
  s_mov_b32 s74, 34816
  buffer_store_dwordx4 v[24:27], v28, s[76:79], s74 offen sc1
  s_mov_b32 s74, 69632
  buffer_store_dwordx4 v[24:27], v28, s[76:79], s74 offen sc1
  s_mov_b32 s74, 104448
  buffer_store_dwordx4 v[24:27], v28, s[76:79], s74 offen sc1
  s_waitcnt vmcnt(0)
  s_mov_b32 s74, 1
  s_atomic_add s74, s[38:39], 128 glc
L_noz:
  s_waitcnt vmcnt(4)
  buffer_load_dwordx4 v[84:87], v60, s[44:47], s52 offen offset:2560 nt
  s_waitcnt vmcnt(4)
  buffer_load_dwordx4 v[88:91], v60, s[44:47], s52 offen offset:3072 nt
  s_waitcnt vmcnt(4)
  buffer_load_dwordx4 v[92:95], v60, s[44:47], s52 offen offset:3584 nt
  s_waitcnt vmcnt(4)
  s_add_u32 s52, s52, 0x4000
  buffer_load_dwordx4 v[96:99], v60, s[44:47], s52 offen offset:0 nt
  s_waitcnt vmcnt(4)
  buffer_load_dwordx4 v[100:103], v60, s[44:47], s52 offen offset:512 nt
  s_waitcnt vmcnt(4)
  buffer_load_dwordx4 v[104:107], v60, s[44:47], s52 offen offset:1024 nt
  s_waitcnt vmcnt(4)
  buffer_load_dwordx4 v[108:111], v60, s[44:47], s52 offen offset:1536 nt
  s_waitcnt vmcnt(4)
  buffer_load_dwordx4 v[112:115], v60, s[44:47], s52 offen offset:2048 nt
  s_waitcnt vmcnt(4)
  buffer_load_dwordx4 v[116:119], v60, s[44:47], s52 offen offset:2560 nt
  s_waitcnt vmcnt(4)
  buffer_load_dwordx4 v[120:123], v60, s[44:47], s52 offen offset:3072 nt
  s_waitcnt vmcnt(4)
  buffer_load_dwordx4 v[124:127], v60, s[44:47], s52 offen offset:3584 nt
  s_waitcnt vmcnt(4)
  s_add_u32 s52, s52, 0xc000
  buffer_load_dwordx4 v[128:131], v60, s[44:47], s52 offen offset:0 nt
  s_waitcnt vmcnt(4)
  buffer_load_dwordx4 v[132:135], v60, s[44:47], s52 offen offset:512 nt
  s_waitcnt vmcnt(4)
  buffer_load_dwordx4 v[136:139], v60, s[44:47], s52 offen offset:1024 nt
  s_waitcnt vmcnt(4)
  buffer_load_dwordx4 v[140:143], v60, s[44:47], s52 offen offset:1536 nt
  s_waitcnt vmcnt(4)
  buffer_load_dwordx4 v[144:147], v60, s[44:47], s52 offen offset:2048 nt
  s_waitcnt vmcnt(4)
  buffer_load_dwordx4 v[148:151], v60, s[44:47], s52 offen offset:2560 nt
  s_waitcnt vmcnt(4)
  buffer_load_dwordx4 v[152:155], v60, s[44:47], s52 offen offset:3072 nt
  s_waitcnt vmcnt(4)
  buffer_load_dwordx4 v[156:159], v60, s[44:47], s52 offen offset:3584 nt
  s_waitcnt vmcnt(4)
  s_add_u32 s52, s52, 0x4000
  buffer_load_dwordx4 v[160:163], v60, s[44:47], s52 offen offset:0 nt
  s_waitcnt vmcnt(4)
  buffer_load_dwordx4 v[164:167], v60, s[44:47], s52 offen offset:512 nt
  s_waitcnt vmcnt(4)
  buffer_load_dwordx4 v[168:171], v60, s[44:47], s52 offen offset:1024 nt
  s_waitcnt vmcnt(4)
  buffer_load_dwordx4 v[172:175], v60, s[44:47], s52 offen offset:1536 nt
  s_waitcnt vmcnt(4)
  buffer_load_dwordx4 v[176:179], v60, s[44:47], s52 offen offset:2048 nt
  s_waitcnt vmcnt(4)
  buffer_load_dwordx4 v[180:183], v60, s[44:47], s52 offen offset:2560 nt
  s_waitcnt vmcnt(4)
  buffer_load_dwordx4 v[184:187], v60, s[44:47], s52 offen offset:3072 nt
  s_waitcnt vmcnt(4)
  buffer_load_dwordx4 v[188:191], v60, s[44:47], s52 offen offset:3584 nt
  s_waitcnt vmcnt(4)
  s_add_u32 s52, s52, 0xc000
  buffer_load_dwordx4 v[192:195], v60, s[44:47], s52 offen offset:0 nt
  s_waitcnt vmcnt(4)
  buffer_load_dwordx4 v[196:199], v60, s[44:47], s52 offen offset:512 nt
  s_waitcnt vmcnt(4)
  buffer_load_dwordx4 v[200:203], v60, s[44:47], s52 offen offset:1024 nt
  s_waitcnt vmcnt(4)
  buffer_load_dwordx4 v[204:207], v60, s[44:47], s52 offen offset:1536 nt
  s_waitcnt vmcnt(4)
  buffer_load_dwordx4 v[208:211], v60, s[44:47], s52 offen offset:2048 nt
  s_waitcnt vmcnt(4)
  buffer_load_dwordx4 v[212:215], v60, s[44:47], s52 offen offset:2560 nt
  s_waitcnt vmcnt(4)
  buffer_load_dwordx4 v[216:219], v60, s[44:47], s52 offen offset:3072 nt
  s_waitcnt vmcnt(4)
  buffer_load_dwordx4 v[220:223], v60, s[44:47], s52 offen offset:3584 nt
  s_waitcnt vmcnt(4)
  s_add_u32 s52, s52, 0x4000
  buffer_load_dwordx4 v[224:227], v60, s[44:47], s52 offen offset:0 nt
  s_waitcnt vmcnt(4)
  buffer_load_dwordx4 v[228:231], v60, s[44:47], s52 offen offset:512 nt
  s_waitcnt vmcnt(4)
  buffer_load_dwordx4 v[232:235], v60, s[44:47], s52 offen offset:1024 nt
  s_waitcnt vmcnt(4)
  buffer_load_dwordx4 v[236:239], v60, s[44:47], s52 offen offset:1536 nt
  s_waitcnt vmcnt(4)
  buffer_load_dwordx4 v[240:243], v60, s[44:47], s52 offen offset:2048 nt
  s_waitcnt vmcnt(4)
  buffer_load_dwordx4 v[244:247], v60, s[44:47], s52 offen offset:2560 nt
  s_waitcnt vmcnt(4)
  buffer_load_dwordx4 v[248:251], v60, s[44:47], s52 offen offset:3072 nt
  s_barrier
  ds_read_b128 v[24:27], v61 offset:0
  ds_read_b128 v[28:31], v61 offset:16
  ds_read_b128 v[32:35], v61 offset:512
  ds_read_b128 v[36:39], v61 offset:528
  ds_read_b128 v[40:43], v61 offset:1024
  ds_read_b128 v[44:47], v61 offset:1040
  ds_read_b128 v[48:51], v61 offset:1536
  ds_read_b128 v[52:55], v61 offset:1552
  s_waitcnt lgkmcnt(0)
  v_add_f32 v24, v24, v32
  v_add_f32 v40, v40, v48
  v_add_f32 v25, v25, v33
  v_add_f32 v41, v41, v49
  v_add_f32 v26, v26, v34
  v_add_f32 v42, v42, v50
  v_add_f32 v27, v27, v35
  v_add_f32 v43, v43, v51
  v_add_f32 v28, v28, v36
  v_add_f32 v44, v44, v52
  v_add_f32 v29, v29, v37
  v_add_f32 v45, v45, v53
  v_add_f32 v30, v30, v38
  v_add_f32 v46, v46, v54
  v_add_f32 v31, v31, v39
  v_add_f32 v47, v47, v55
  v_add_f32 v24, v24, v40
  v_add_f32 v25, v25, v41
  v_add_f32 v26, v26, v42
  v_add_f32 v27, v27, v43
  v_add_f32 v28, v28, v44
  v_add_f32 v29, v29, v45
  v_add_f32 v30, v30, v46
  v_add_f32 v31, v31, v47
  v_cvt_pk_bf16_f32 v4, v24, v25
  v_cvt_pk_bf16_f32 v5, v26, v27
  v_cvt_pk_bf16_f32 v6, v28, v29
  v_cvt_pk_bf16_f32 v7, v30, v31
  v_mov_b32 v57, 0
  v_mov_b32 v56, 1
  s_mov_b32 s53, 0
L_kloop:
  v_dot2_f32_bf16 v24, v64, v4, 0
  v_dot2_f32_bf16 v24, v65, v5, v24
  v_dot2_f32_bf16 v24, v66, v6, v24
  v_dot2_f32_bf16 v24, v67, v7, v24
  v_add_f32_dpp v29, v26, v26 row_ror:8 row_mask:0xf bank_mask:0x3
  v_add_f32_dpp v29, v27, v27 row_ror:8 row_mask:0xf bank_mask:0xc
  s_cbranch_vccz L_w1h
  s_bitcmp0_b32 vcc_lo, 1
  s_cbranch_scc1 L_w1m
  s_waitcnt vmcnt(3)
L_w1m:
  s_waitcnt vmcnt(4)
L_w1h:
  s_waitcnt vmcnt(5)
  buffer_load_dwordx4 v[252:255], v60, s[44:47], s52 offen offset:3584 nt
  s_mov_b32 vcc_lo, s84
  v_dot2_f32_bf16 v25, v68, v4, 0
  v_dot2_f32_bf16 v25, v69, v5, v25
  v_dot2_f32_bf16 v25, v70, v6, v25
  v_dot2_f32_bf16 v25, v71, v7, v25
  v_add_f32_dpp v31, v28, v28 row_shl:4 row_mask:0xf bank_mask:0x5
  v_add_f32_dpp v31, v29, v29 row_shr:4 row_mask:0xf bank_mask:0xa
  s_cbranch_vccz L_w2h
  s_bitcmp0_b32 vcc_lo, 1
  s_cbranch_scc1 L_w2m
  s_waitcnt vmcnt(3)
L_w2m:
  s_waitcnt vmcnt(4)
L_w2h:
  s_waitcnt vmcnt(5)
  s_add_u32 s52, s52, 0xc000
  buffer_load_dwordx4 v[64:67], v60, s[44:47], s52 offen offset:0 nt
  s_add_u32 s63, s63, 1
  ds_read_b64 v[58:59], v57 offset:5192
  v_mov_b32 v0, s63
  v_lshlrev_b32 v0, 2, v0
  s_mov_b64 exec, 1
  ds_add_rtn_u32 v51, v0, v56 offset:5376
  s_mov_b64 exec, -1
  s_and_b32 s71, s63, 1
  s_cselect_b32 s71, 0, s66
  s_cmp_eq_u32 s71, 0
  s_cbranch_scc1 L_w3
  s_lshr_b32 s67, s63, 1
  s_and_b32 s69, s67, 3
  s_lshl_b32 s69, s69, 2
  s_lshr_b32 s69, 0x5030, s69
  s_and_b32 s69, s69, 15
  s_bfm_b32 s70, s69, 0
  s_and_b32 s70, s70, s2
  s_add_u32 s68, s69, 3
  s_lshr_b32 s68, s2, s68
  s_lshl_b32 s68, s68, s69
  s_or_b32 s68, s68, s70
  s_mul_i32 s68, s68, 4352
  s_lshl_b32 s69, s63, 2
  s_add_u32 s69, s69, s68
  s_mov_b32 s68, 1
  s_atomic_add s68, s[64:65], s69 glc
L_w3:
  v_dot2_f32_bf16 v26, v72, v4, 0
  v_dot2_f32_bf16 v26, v73, v5, v26
  v_dot2_f32_bf16 v26, v74, v6, v26
  v_dot2_f32_bf16 v26, v75, v7, v26
  v_add_f32_dpp v28, v24, v24 row_ror:8 row_mask:0xf bank_mask:0x3
  v_add_f32_dpp v28, v25, v25 row_ror:8 row_mask:0xf bank_mask:0xc
  s_cbranch_vccz L_w4h
  s_bitcmp0_b32 vcc_lo, 1
  s_cbranch_scc1 L_w4m
  s_waitcnt vmcnt(3)
L_w4m:
  s_waitcnt vmcnt(4)
L_w4h:
  s_waitcnt vmcnt(5)
  buffer_load_dwordx4 v[68:71], v60, s[44:47], s52 offen offset:512 nt
  v_dot2_f32_bf16 v27, v76, v4, 0
  v_dot2_f32_bf16 v27, v77, v5, v27
  v_dot2_f32_bf16 v27, v78, v6, v27
  v_dot2_f32_bf16 v27, v79, v7, v27
  v_add_f32_dpp v52, v30, v30 quad_perm:[2,3,0,1] row_mask:0xf bank_mask:0xf
  v_add_f32_dpp v53, v31, v31 quad_perm:[2,3,0,1] row_mask:0xf bank_mask:0xf
  v_cndmask_b32 v33, v52, v53, s[54:55]
  s_cbranch_vccz L_w5h
  s_bitcmp0_b32 vcc_lo, 1
  s_cbranch_scc1 L_w5m
  s_waitcnt vmcnt(3)
L_w5m:
  s_waitcnt vmcnt(4)
L_w5h:
  s_waitcnt vmcnt(5)
  buffer_load_dwordx4 v[72:75], v60, s[44:47], s52 offen offset:1024 nt
  v_dot2_f32_bf16 v24, v80, v4, 0
  v_dot2_f32_bf16 v24, v81, v5, v24
  v_dot2_f32_bf16 v24, v82, v6, v24
  v_dot2_f32_bf16 v24, v83, v7, v24
  v_add_f32_dpp v29, v26, v26 row_ror:8 row_mask:0xf bank_mask:0x3
  v_add_f32_dpp v29, v27, v27 row_ror:8 row_mask:0xf bank_mask:0xc
  s_cbranch_vccz L_w6h
  s_bitcmp0_b32 vcc_lo, 1
  s_cbranch_scc1 L_w6m
  s_waitcnt vmcnt(3)
L_w6m:
  s_waitcnt vmcnt(4)
L_w6h:
  s_waitcnt vmcnt(5)
  buffer_load_dwordx4 v[76:79], v60, s[44:47], s52 offen offset:1536 nt
  v_dot2_f32_bf16 v25, v84, v4, 0
  v_dot2_f32_bf16 v25, v85, v5, v25
  v_dot2_f32_bf16 v25, v86, v6, v25
  v_dot2_f32_bf16 v25, v87, v7, v25
  v_add_f32_dpp v30, v28, v28 row_shl:4 row_mask:0xf bank_mask:0x5
  v_add_f32_dpp v30, v29, v29 row_shr:4 row_mask:0xf bank_mask:0xa
  v_add_f32_dpp v52, v32, v32 quad_perm:[1,0,3,2] row_mask:0xf bank_mask:0xf
  v_add_f32_dpp v53, v33, v33 quad_perm:[1,0,3,2] row_mask:0xf bank_mask:0xf
  v_cndmask_b32 v52, v52, v53, s[56:57]
  v_cvt_pk_bf16_f32 v52, v52, v52
  v_lshlrev_b32 v52, 16, v52
  v_mul_f32 v52, 0x3db504f3, v52
  v_cvt_pk_bf16_f32 v52, v52, v52
  v_lshlrev_b32 v45, 16, v52
  s_cbranch_vccz L_w7h
  s_bitcmp0_b32 vcc_lo, 1
  s_cbranch_scc1 L_w7m
  s_waitcnt vmcnt(3)
L_w7m:
  s_waitcnt vmcnt(4)
L_w7h:
  s_waitcnt vmcnt(5)
  buffer_load_dwordx4 v[80:83], v60, s[44:47], s52 offen offset:2048 nt
  v_dot2_f32_bf16 v26, v88, v4, 0
  v_dot2_f32_bf16 v26, v89, v5, v26
  v_dot2_f32_bf16 v26, v90, v6, v26
  v_dot2_f32_bf16 v26, v91, v7, v26
  v_add_f32_dpp v28, v24, v24 row_ror:8 row_mask:0xf bank_mask:0x3
  v_add_f32_dpp v28, v25, v25 row_ror:8 row_mask:0xf bank_mask:0xc
  s_cbranch_vccz L_w8h
  s_bitcmp0_b32 vcc_lo, 1
  s_cbranch_scc1 L_w8m
  s_waitcnt vmcnt(3)
L_w8m:
  s_waitcnt vmcnt(4)
L_w8h:
  s_waitcnt vmcnt(5)
  buffer_load_dwordx4 v[84:87], v60, s[44:47], s52 offen offset:2560 nt
  v_dot2_f32_bf16 v27, v92, v4, 0
  v_dot2_f32_bf16 v27, v93, v5, v27
  v_dot2_f32_bf16 v27, v94, v6, v27
  v_dot2_f32_bf16 v27, v95, v7, v27
  v_mov_b32 v34, v37
  s_cbranch_vccz L_w9h
  s_bitcmp0_b32 vcc_lo, 1
  s_cbranch_scc1 L_w9m
  s_waitcnt vmcnt(3)
L_w9m:
  s_waitcnt vmcnt(4)
L_w9h:
  s_waitcnt vmcnt(5)
  buffer_load_dwordx4 v[88:91], v60, s[44:47], s52 offen offset:3072 nt
  v_dot2_f32_bf16 v24, v96, v4, 0
  v_dot2_f32_bf16 v24, v97, v5, v24
  v_dot2_f32_bf16 v24, v98, v6, v24
  v_dot2_f32_bf16 v24, v99, v7, v24
  v_add_f32_dpp v29, v26, v26 row_ror:8 row_mask:0xf bank_mask:0x3
  v_add_f32_dpp v29, v27, v27 row_ror:8 row_mask:0xf bank_mask:0xc
  v_mov_b32 v35, v38
  s_cbranch_vccz L_w10h
  s_bitcmp0_b32 vcc_lo, 1
  s_cbranch_scc1 L_w10m
  s_waitcnt vmcnt(3)
L_w10m:
  s_waitcnt vmcnt(4)
L_w10h:
  s_waitcnt vmcnt(5)
  buffer_load_dwordx4 v[92:95], v60, s[44:47], s52 offen offset:3584 nt
  v_dot2_f32_bf16 v25, v100, v4, 0
  v_dot2_f32_bf16 v25, v101, v5, v25
  v_dot2_f32_bf16 v25, v102, v6, v25
  v_dot2_f32_bf16 v25, v103, v7, v25
  v_add_f32_dpp v31, v28, v28 row_shl:4 row_mask:0xf bank_mask:0x5
  v_add_f32_dpp v31, v29, v29 row_shr:4 row_mask:0xf bank_mask:0xa
  v_mov_b32 v36, v39
  s_cbranch_vccz L_w11h
  s_bitcmp0_b32 vcc_lo, 1
  s_cbranch_scc1 L_w11m
  s_waitcnt vmcnt(3)
L_w11m:
  s_waitcnt vmcnt(4)
L_w11h:
  s_waitcnt vmcnt(5)
  s_add_u32 s52, s52, 0x4000
  buffer_load_dwordx4 v[96:99], v60, s[44:47], s52 offen offset:0 nt
  s_waitcnt lgkmcnt(0)
  v_readfirstlane_b32 s66, v58
  v_readfirstlane_b32 s70, v59
  s_and_b32 s66, s66, s72
  s_cmp_eq_u32 s71, 0
  s_cbranch_scc1 L_w12
  s_cmp_lt_u32 s68, 7
  s_cselect_b32 s70, 5, 4
  s_cmp_lt_u32 s68, 1
  s_cselect_b32 s70, 7, s70
  v_mov_b32 v59, s70
  ds_write_b32 v57, v59 offset:5196
L_w12:
  s_cmp_eq_u32 s70, 0
  s_cselect_b32 s70, 1, s70
  s_and_b32 s84, s70, 3
  v_readfirstlane_b32 s69, v51
  s_lshr_b32 s70, s84, 1
  s_cmp_eq_u32 s69, 3
  s_cselect_b32 vcc_lo, s70, s84
  s_lshl_b32 s70, s84, 1
  s_or_b32 s70, s70, 1
  s_and_b32 s70, s70, 3
  s_cmp_eq_u32 s69, 0
  s_cselect_b32 vcc_lo, s70, vcc_lo
  v_dot2_f32_bf16 v26, v104, v4, 0
  v_dot2_f32_bf16 v26, v105, v5, v26
  v_dot2_f32_bf16 v26, v106, v6, v26
  v_dot2_f32_bf16 v26, v107, v7, v26
  v_add_f32_dpp v28, v24, v24 row_ror:8 row_mask:0xf bank_mask:0x3
  v_add_f32_dpp v28, v25, v25 row_ror:8 row_mask:0xf bank_mask:0xc
  v_mov_b32 v37, v40
  s_cbranch_vccz L_w13h
  s_bitcmp0_b32 vcc_lo, 1
  s_cbranch_scc1 L_w13m
  s_waitcnt vmcnt(3)
L_w13m:
  s_waitcnt vmcnt(4)
L_w13h:
  s_waitcnt vmcnt(5)
  buffer_load_dwordx4 v[100:103], v60, s[44:47], s52 offen offset:512 nt
  v_dot2_f32_bf16 v27, v108, v4, 0
  v_dot2_f32_bf16 v27, v109, v5, v27
  v_dot2_f32_bf16 v27, v110, v6, v27
  v_dot2_f32_bf16 v27, v111, v7, v27
  v_add_f32_dpp v52, v30, v30 quad_perm:[2,3,0,1] row_mask:0xf bank_mask:0xf
  v_add_f32_dpp v53, v31, v31 quad_perm:[2,3,0,1] row_mask:0xf bank_mask:0xf
  v_cndmask_b32 v32, v52, v53, s[54:55]
  v_mov_b32 v38, v41
  s_cbranch_vccz L_w14h
  s_bitcmp0_b32 vcc_lo, 1
  s_cbranch_scc1 L_w14m
  s_waitcnt vmcnt(3)
L_w14m:
  s_waitcnt vmcnt(4)
L_w14h:
  s_waitcnt vmcnt(5)
  buffer_load_dwordx4 v[104:107], v60, s[44:47], s52 offen offset:1024 nt
  v_dot2_f32_bf16 v24, v112, v4, 0
  v_dot2_f32_bf16 v24, v113, v5, v24
  v_dot2_f32_bf16 v24, v114, v6, v24
  v_dot2_f32_bf16 v24, v115, v7, v24
  v_add_f32_dpp v29, v26, v26 row_ror:8 row_mask:0xf bank_mask:0x3
  v_add_f32_dpp v29, v27, v27 row_ror:8 row_mask:0xf bank_mask:0xc
  v_mov_b32 v39, v42
  s_cbranch_vccz L_w15h
  s_bitcmp0_b32 vcc_lo, 1
  s_cbranch_scc1 L_w15m
  s_waitcnt vmcnt(3)
L_w15m:
  s_waitcnt vmcnt(4)
L_w15h:
  s_waitcnt vmcnt(5)
  buffer_load_dwordx4 v[108:111], v60, s[44:47], s52 offen offset:1536 nt
  v_dot2_f32_bf16 v25, v116, v4, 0
  v_dot2_f32_bf16 v25, v117, v5, v25
  v_dot2_f32_bf16 v25, v118, v6, v25
  v_dot2_f32_bf16 v25, v119, v7, v25
  v_add_f32_dpp v30, v28, v28 row_shl:4 row_mask:0xf bank_mask:0x5
  v_add_f32_dpp v30, v29, v29 row_shr:4 row_mask:0xf bank_mask:0xa
  v_mov_b32 v40, v43
  s_cbranch_vccz L_w16h
  s_bitcmp0_b32 vcc_lo, 1
  s_cbranch_scc1 L_w16m
  s_waitcnt vmcnt(3)
L_w16m:
  s_waitcnt vmcnt(4)
L_w16h:
  s_waitcnt vmcnt(5)
  buffer_load_dwordx4 v[112:115], v60, s[44:47], s52 offen offset:2048 nt
  v_dot2_f32_bf16 v26, v120, v4, 0
  v_dot2_f32_bf16 v26, v121, v5, v26
  v_dot2_f32_bf16 v26, v122, v6, v26
  v_dot2_f32_bf16 v26, v123, v7, v26
  v_add_f32_dpp v28, v24, v24 row_ror:8 row_mask:0xf bank_mask:0x3
  v_add_f32_dpp v28, v25, v25 row_ror:8 row_mask:0xf bank_mask:0xc
  v_mov_b32 v41, v44
  s_cbranch_vccz L_w17h
  s_bitcmp0_b32 vcc_lo, 1
  s_cbranch_scc1 L_w17m
  s_waitcnt vmcnt(3)
L_w17m:
  s_waitcnt vmcnt(4)
L_w17h:
  s_waitcnt vmcnt(5)
  buffer_load_dwordx4 v[116:119], v60, s[44:47], s52 offen offset:2560 nt
  v_dot2_f32_bf16 v27, v124, v4, 0
  v_dot2_f32_bf16 v27, v125, v5, v27
  v_dot2_f32_bf16 v27, v126, v6, v27
  v_dot2_f32_bf16 v27, v127, v7, v27
  v_mov_b32 v42, v45
  s_cbranch_vccz L_w18h
  s_bitcmp0_b32 vcc_lo, 1
  s_cbranch_scc1 L_w18m
  s_waitcnt vmcnt(3)
L_w18m:
  s_waitcnt vmcnt(4)
L_w18h:
  s_waitcnt vmcnt(5)
  buffer_load_dwordx4 v[120:123], v60, s[44:47], s52 offen offset:3072 nt
  v_dot2_f32_bf16 v24, v128, v4, 0
  v_dot2_f32_bf16 v24, v129, v5, v24
  v_dot2_f32_bf16 v24, v130, v6, v24
  v_dot2_f32_bf16 v24, v131, v7, v24
  v_add_f32_dpp v29, v26, v26 row_ror:8 row_mask:0xf bank_mask:0x3
  v_add_f32_dpp v29, v27, v27 row_ror:8 row_mask:0xf bank_mask:0xc
  s_cbranch_vccz L_w19h
  s_bitcmp0_b32 vcc_lo, 1
  s_cbranch_scc1 L_w19m
  s_waitcnt vmcnt(3)
L_w19m:
  s_waitcnt vmcnt(4)
L_w19h:
  s_waitcnt vmcnt(5)
  buffer_load_dwordx4 v[124:127], v60, s[44:47], s52 offen offset:3584 nt
  s_mov_b32 vcc_lo, s84
  v_dot2_f32_bf16 v25, v132, v4, 0
  v_dot2_f32_bf16 v25, v133, v5, v25
  v_dot2_f32_bf16 v25, v134, v6, v25
  v_dot2_f32_bf16 v25, v135, v7, v25
  v_add_f32_dpp v31, v28, v28 row_shl:4 row_mask:0xf bank_mask:0x5
  v_add_f32_dpp v31, v29, v29 row_shr:4 row_mask:0xf bank_mask:0xa
  s_cbranch_vccz L_w20h
  s_bitcmp0_b32 vcc_lo, 1
  s_cbranch_scc1 L_w20m
  s_waitcnt vmcnt(3)
L_w20m:
  s_waitcnt vmcnt(4)
L_w20h:
  s_waitcnt vmcnt(5)
  s_add_u32 s52, s52, 0xc000
  buffer_load_dwordx4 v[128:131], v60, s[44:47], s52 offen offset:0 nt
  s_add_u32 s63, s63, 1
  ds_read_b64 v[58:59], v57 offset:5192
  v_mov_b32 v0, s63
  v_lshlrev_b32 v0, 2, v0
  s_mov_b64 exec, 1
  ds_add_rtn_u32 v51, v0, v56 offset:5376
  s_mov_b64 exec, -1
  s_and_b32 s71, s63, 1
  s_cselect_b32 s71, 0, s66
  s_cmp_eq_u32 s71, 0
  s_cbranch_scc1 L_w21
  s_lshr_b32 s67, s63, 1
  s_and_b32 s69, s67, 3
  s_lshl_b32 s69, s69, 2
  s_lshr_b32 s69, 0x5030, s69
  s_and_b32 s69, s69, 15
  s_bfm_b32 s70, s69, 0
  s_and_b32 s70, s70, s2
  s_add_u32 s68, s69, 3
  s_lshr_b32 s68, s2, s68
  s_lshl_b32 s68, s68, s69
  s_or_b32 s68, s68, s70
  s_mul_i32 s68, s68, 4352
  s_lshl_b32 s69, s63, 2
  s_add_u32 s69, s69, s68
  s_mov_b32 s68, 1
  s_atomic_add s68, s[64:65], s69 glc
L_w21:
  v_dot2_f32_bf16 v26, v136, v4, 0
  v_dot2_f32_bf16 v26, v137, v5, v26
  v_dot2_f32_bf16 v26, v138, v6, v26
  v_dot2_f32_bf16 v26, v139, v7, v26
  v_add_f32_dpp v28, v24, v24 row_ror:8 row_mask:0xf bank_mask:0x3
  v_add_f32_dpp v28, v25, v25 row_ror:8 row_mask:0xf bank_mask:0xc
  s_cbranch_vccz L_w22h
  s_bitcmp0_b32 vcc_lo, 1
  s_cbranch_scc1 L_w22m
  s_waitcnt vmcnt(3)
L_w22m:
  s_waitcnt vmcnt(4)
L_w22h:
  s_waitcnt vmcnt(5)
  buffer_load_dwordx4 v[132:135], v60, s[44:47], s52 offen offset:512 nt
  v_dot2_f32_bf16 v27, v140, v4, 0
  v_dot2_f32_bf16 v27, v141, v5, v27
  v_dot2_f32_bf16 v27, v142, v6, v27
  v_dot2_f32_bf16 v27, v143, v7, v27
  v_add_f32_dpp v52, v30, v30 quad_perm:[2,3,0,1] row_mask:0xf bank_mask:0xf
  v_add_f32_dpp v53, v31, v31 quad_perm:[2,3,0,1] row_mask:0xf bank_mask:0xf
  v_cndmask_b32 v33, v52, v53, s[54:55]
  s_cbranch_vccz L_w23h
  s_bitcmp0_b32 vcc_lo, 1
  s_cbranch_scc1 L_w23m
  s_waitcnt vmcnt(3)
L_w23m:
  s_waitcnt vmcnt(4)
L_w23h:
  s_waitcnt vmcnt(5)
  buffer_load_dwordx4 v[136:139], v60, s[44:47], s52 offen offset:1024 nt
  v_dot2_f32_bf16 v24, v144, v4, 0
  v_dot2_f32_bf16 v24, v145, v5, v24
  v_dot2_f32_bf16 v24, v146, v6, v24
  v_dot2_f32_bf16 v24, v147, v7, v24
  v_add_f32_dpp v29, v26, v26 row_ror:8 row_mask:0xf bank_mask:0x3
  v_add_f32_dpp v29, v27, v27 row_ror:8 row_mask:0xf bank_mask:0xc
  s_cbranch_vccz L_w24h
  s_bitcmp0_b32 vcc_lo, 1
  s_cbranch_scc1 L_w24m
  s_waitcnt vmcnt(3)
L_w24m:
  s_waitcnt vmcnt(4)
L_w24h:
  s_waitcnt vmcnt(5)
  buffer_load_dwordx4 v[140:143], v60, s[44:47], s52 offen offset:1536 nt
  v_dot2_f32_bf16 v25, v148, v4, 0
  v_dot2_f32_bf16 v25, v149, v5, v25
  v_dot2_f32_bf16 v25, v150, v6, v25
  v_dot2_f32_bf16 v25, v151, v7, v25
  v_add_f32_dpp v30, v28, v28 row_shl:4 row_mask:0xf bank_mask:0x5
  v_add_f32_dpp v30, v29, v29 row_shr:4 row_mask:0xf bank_mask:0xa
  v_add_f32_dpp v52, v32, v32 quad_perm:[1,0,3,2] row_mask:0xf bank_mask:0xf
  v_add_f32_dpp v53, v33, v33 quad_perm:[1,0,3,2] row_mask:0xf bank_mask:0xf
  v_cndmask_b32 v52, v52, v53, s[56:57]
  v_cvt_pk_bf16_f32 v52, v52, v52
  v_lshlrev_b32 v52, 16, v52
  v_mul_f32 v52, 0x3db504f3, v52
  v_cvt_pk_bf16_f32 v52, v52, v52
  v_lshlrev_b32 v43, 16, v52
  s_cbranch_vccz L_w25h
  s_bitcmp0_b32 vcc_lo, 1
  s_cbranch_scc1 L_w25m
  s_waitcnt vmcnt(3)
L_w25m:
  s_waitcnt vmcnt(4)
L_w25h:
  s_waitcnt vmcnt(5)
  buffer_load_dwordx4 v[144:147], v60, s[44:47], s52 offen offset:2048 nt
  v_dot2_f32_bf16 v26, v152, v4, 0
  v_dot2_f32_bf16 v26, v153, v5, v26
  v_dot2_f32_bf16 v26, v154, v6, v26
  v_dot2_f32_bf16 v26, v155, v7, v26
  v_add_f32_dpp v28, v24, v24 row_ror:8 row_mask:0xf bank_mask:0x3
  v_add_f32_dpp v28, v25, v25 row_ror:8 row_mask:0xf bank_mask:0xc
  s_cbranch_vccz L_w26h
  s_bitcmp0_b32 vcc_lo, 1
  s_cbranch_scc1 L_w26m
  s_waitcnt vmcnt(3)
L_w26m:
  s_waitcnt vmcnt(4)
L_w26h:
  s_waitcnt vmcnt(5)
  buffer_load_dwordx4 v[148:151], v60, s[44:47], s52 offen offset:2560 nt
  v_dot2_f32_bf16 v27, v156, v4, 0
  v_dot2_f32_bf16 v27, v157, v5, v27
  v_dot2_f32_bf16 v27, v158, v6, v27
  v_dot2_f32_bf16 v27, v159, v7, v27
  s_cbranch_vccz L_w27h
  s_bitcmp0_b32 vcc_lo, 1
  s_cbranch_scc1 L_w27m
  s_waitcnt vmcnt(3)
L_w27m:
  s_waitcnt vmcnt(4)
L_w27h:
  s_waitcnt vmcnt(5)
  buffer_load_dwordx4 v[152:155], v60, s[44:47], s52 offen offset:3072 nt
  v_dot2_f32_bf16 v24, v160, v4, 0
  v_dot2_f32_bf16 v24, v161, v5, v24
  v_dot2_f32_bf16 v24, v162, v6, v24
  v_dot2_f32_bf16 v24, v163, v7, v24
  v_add_f32_dpp v29, v26, v26 row_ror:8 row_mask:0xf bank_mask:0x3
  v_add_f32_dpp v29, v27, v27 row_ror:8 row_mask:0xf bank_mask:0xc
  s_cbranch_vccz L_w28h
  s_bitcmp0_b32 vcc_lo, 1
  s_cbranch_scc1 L_w28m
  s_waitcnt vmcnt(3)
L_w28m:
  s_waitcnt vmcnt(4)
L_w28h:
  s_waitcnt vmcnt(5)
  buffer_load_dwordx4 v[156:159], v60, s[44:47], s52 offen offset:3584 nt
  v_dot2_f32_bf16 v25, v164, v4, 0
  v_dot2_f32_bf16 v25, v165, v5, v25
  v_dot2_f32_bf16 v25, v166, v6, v25
  v_dot2_f32_bf16 v25, v167, v7, v25
  v_add_f32_dpp v31, v28, v28 row_shl:4 row_mask:0xf bank_mask:0x5
  v_add_f32_dpp v31, v29, v29 row_shr:4 row_mask:0xf bank_mask:0xa
  s_cbranch_vccz L_w29h
  s_bitcmp0_b32 vcc_lo, 1
  s_cbranch_scc1 L_w29m
  s_waitcnt vmcnt(3)
L_w29m:
  s_waitcnt vmcnt(4)
L_w29h:
  s_waitcnt vmcnt(5)
  s_add_u32 s52, s52, 0x4000
  buffer_load_dwordx4 v[160:163], v60, s[44:47], s52 offen offset:0 nt
  s_waitcnt lgkmcnt(0)
  v_readfirstlane_b32 s66, v58
  v_readfirstlane_b32 s70, v59
  s_and_b32 s66, s66, s72
  s_cmp_eq_u32 s71, 0
  s_cbranch_scc1 L_w30
  s_cmp_lt_u32 s68, 7
  s_cselect_b32 s70, 5, 4
  s_cmp_lt_u32 s68, 1
  s_cselect_b32 s70, 7, s70
  v_mov_b32 v59, s70
  ds_write_b32 v57, v59 offset:5196
L_w30:
  s_cmp_eq_u32 s70, 0
  s_cselect_b32 s70, 1, s70
  s_and_b32 s84, s70, 3
  v_readfirstlane_b32 s69, v51
  s_lshr_b32 s70, s84, 1
  s_cmp_eq_u32 s69, 3
  s_cselect_b32 vcc_lo, s70, s84
  s_lshl_b32 s70, s84, 1
  s_or_b32 s70, s70, 1
  s_and_b32 s70, s70, 3
  s_cmp_eq_u32 s69, 0
  s_cselect_b32 vcc_lo, s70, vcc_lo
  v_dot2_f32_bf16 v26, v168, v4, 0
  v_dot2_f32_bf16 v26, v169, v5, v26
  v_dot2_f32_bf16 v26, v170, v6, v26
  v_dot2_f32_bf16 v26, v171, v7, v26
  v_add_f32_dpp v28, v24, v24 row_ror:8 row_mask:0xf bank_mask:0x3
  v_add_f32_dpp v28, v25, v25 row_ror:8 row_mask:0xf bank_mask:0xc
  s_cbranch_vccz L_w31h
  s_bitcmp0_b32 vcc_lo, 1
  s_cbranch_scc1 L_w31m
  s_waitcnt vmcnt(3)
L_w31m:
  s_waitcnt vmcnt(4)
L_w31h:
  s_waitcnt vmcnt(5)
  buffer_load_dwordx4 v[164:167], v60, s[44:47], s52 offen offset:512 nt
  v_dot2_f32_bf16 v27, v172, v4, 0
  v_dot2_f32_bf16 v27, v173, v5, v27
  v_dot2_f32_bf16 v27, v174, v6, v27
  v_dot2_f32_bf16 v27, v175, v7, v27
  v_add_f32_dpp v52, v30, v30 quad_perm:[2,3,0,1] row_mask:0xf bank_mask:0xf
  v_add_f32_dpp v53, v31, v31 quad_perm:[2,3,0,1] row_mask:0xf bank_mask:0xf
  v_cndmask_b32 v32, v52, v53, s[54:55]
  s_cbranch_vccz L_w32h
  s_bitcmp0_b32 vcc_lo, 1
  s_cbranch_scc1 L_w32m
  s_waitcnt vmcnt(3)
L_w32m:
  s_waitcnt vmcnt(4)
L_w32h:
  s_waitcnt vmcnt(5)
  buffer_load_dwordx4 v[168:171], v60, s[44:47], s52 offen offset:1024 nt
  v_dot2_f32_bf16 v24, v176, v4, 0
  v_dot2_f32_bf16 v24, v177, v5, v24
  v_dot2_f32_bf16 v24, v178, v6, v24
  v_dot2_f32_bf16 v24, v179, v7, v24
  v_add_f32_dpp v29, v26, v26 row_ror:8 row_mask:0xf bank_mask:0x3
  v_add_f32_dpp v29, v27, v27 row_ror:8 row_mask:0xf bank_mask:0xc
  s_cbranch_vccz L_w33h
  s_bitcmp0_b32 vcc_lo, 1
  s_cbranch_scc1 L_w33m
  s_waitcnt vmcnt(3)
L_w33m:
  s_waitcnt vmcnt(4)
L_w33h:
  s_waitcnt vmcnt(5)
  buffer_load_dwordx4 v[172:175], v60, s[44:47], s52 offen offset:1536 nt
  v_dot2_f32_bf16 v25, v180, v4, 0
  v_dot2_f32_bf16 v25, v181, v5, v25
  v_dot2_f32_bf16 v25, v182, v6, v25
  v_dot2_f32_bf16 v25, v183, v7, v25
  v_add_f32_dpp v30, v28, v28 row_shl:4 row_mask:0xf bank_mask:0x5
  v_add_f32_dpp v30, v29, v29 row_shr:4 row_mask:0xf bank_mask:0xa
  s_cbranch_vccz L_w34h
  s_bitcmp0_b32 vcc_lo, 1
  s_cbranch_scc1 L_w34m
  s_waitcnt vmcnt(3)
L_w34m:
  s_waitcnt vmcnt(4)
L_w34h:
  s_waitcnt vmcnt(5)
  buffer_load_dwordx4 v[176:179], v60, s[44:47], s52 offen offset:2048 nt
  v_dot2_f32_bf16 v26, v184, v4, 0
  v_dot2_f32_bf16 v26, v185, v5, v26
  v_dot2_f32_bf16 v26, v186, v6, v26
  v_dot2_f32_bf16 v26, v187, v7, v26
  v_add_f32_dpp v28, v24, v24 row_ror:8 row_mask:0xf bank_mask:0x3
  v_add_f32_dpp v28, v25, v25 row_ror:8 row_mask:0xf bank_mask:0xc
  s_cbranch_vccz L_w35h
  s_bitcmp0_b32 vcc_lo, 1
  s_cbranch_scc1 L_w35m
  s_waitcnt vmcnt(3)
L_w35m:
  s_waitcnt vmcnt(4)
L_w35h:
  s_waitcnt vmcnt(5)
  buffer_load_dwordx4 v[180:183], v60, s[44:47], s52 offen offset:2560 nt
  v_dot2_f32_bf16 v27, v188, v4, 0
  v_dot2_f32_bf16 v27, v189, v5, v27
  v_dot2_f32_bf16 v27, v190, v6, v27
  v_dot2_f32_bf16 v27, v191, v7, v27
  s_cbranch_vccz L_w36h
  s_bitcmp0_b32 vcc_lo, 1
  s_cbranch_scc1 L_w36m
  s_waitcnt vmcnt(3)
L_w36m:
  s_waitcnt vmcnt(4)
L_w36h:
  s_waitcnt vmcnt(5)
  buffer_load_dwordx4 v[184:187], v60, s[44:47], s52 offen offset:3072 nt
  v_dot2_f32_bf16 v24, v192, v4, 0
  v_dot2_f32_bf16 v24, v193, v5, v24
  v_dot2_f32_bf16 v24, v194, v6, v24
  v_dot2_f32_bf16 v24, v195, v7, v24
  v_add_f32_dpp v29, v26, v26 row_ror:8 row_mask:0xf bank_mask:0x3
  v_add_f32_dpp v29, v27, v27 row_ror:8 row_mask:0xf bank_mask:0xc
  s_cbranch_vccz L_w37h
  s_bitcmp0_b32 vcc_lo, 1
  s_cbranch_scc1 L_w37m
  s_waitcnt vmcnt(3)
L_w37m:
  s_waitcnt vmcnt(4)
L_w37h:
  s_waitcnt vmcnt(5)
  buffer_load_dwordx4 v[188:191], v60, s[44:47], s52 offen offset:3584 nt
  s_mov_b32 vcc_lo, s84
  v_dot2_f32_bf16 v25, v196, v4, 0
  v_dot2_f32_bf16 v25, v197, v5, v25
  v_dot2_f32_bf16 v25, v198, v6, v25
  v_dot2_f32_bf16 v25, v199, v7, v25
  v_add_f32_dpp v31, v28, v28 row_shl:4 row_mask:0xf bank_mask:0x5
  v_add_f32_dpp v31, v29, v29 row_shr:4 row_mask:0xf bank_mask:0xa
  s_cbranch_vccz L_w38h
  s_bitcmp0_b32 vcc_lo, 1
  s_cbranch_scc1 L_w38m
  s_waitcnt vmcnt(3)
L_w38m:
  s_waitcnt vmcnt(4)
L_w38h:
  s_waitcnt vmcnt(5)
  s_add_u32 s52, s52, 0xc000
  buffer_load_dwordx4 v[192:195], v60, s[44:47], s52 offen offset:0 nt
  s_add_u32 s63, s63, 1
  ds_read_b64 v[58:59], v57 offset:5192
  v_mov_b32 v0, s63
  v_lshlrev_b32 v0, 2, v0
  s_mov_b64 exec, 1
  ds_add_rtn_u32 v51, v0, v56 offset:5376
  s_mov_b64 exec, -1
  s_and_b32 s71, s63, 1
  s_cselect_b32 s71, 0, s66
  s_cmp_eq_u32 s71, 0
  s_cbranch_scc1 L_w39
  s_lshr_b32 s67, s63, 1
  s_and_b32 s69, s67, 3
  s_lshl_b32 s69, s69, 2
  s_lshr_b32 s69, 0x5030, s69
  s_and_b32 s69, s69, 15
  s_bfm_b32 s70, s69, 0
  s_and_b32 s70, s70, s2
  s_add_u32 s68, s69, 3
  s_lshr_b32 s68, s2, s68
  s_lshl_b32 s68, s68, s69
  s_or_b32 s68, s68, s70
  s_mul_i32 s68, s68, 4352
  s_lshl_b32 s69, s63, 2
  s_add_u32 s69, s69, s68
  s_mov_b32 s68, 1
  s_atomic_add s68, s[64:65], s69 glc
L_w39:
  v_dot2_f32_bf16 v26, v200, v4, 0
  v_dot2_f32_bf16 v26, v201, v5, v26
  v_dot2_f32_bf16 v26, v202, v6, v26
  v_dot2_f32_bf16 v26, v203, v7, v26
  v_add_f32_dpp v28, v24, v24 row_ror:8 row_mask:0xf bank_mask:0x3
  v_add_f32_dpp v28, v25, v25 row_ror:8 row_mask:0xf bank_mask:0xc
  s_cbranch_vccz L_w40h
  s_bitcmp0_b32 vcc_lo, 1
  s_cbranch_scc1 L_w40m
  s_waitcnt vmcnt(3)
L_w40m:
  s_waitcnt vmcnt(4)
L_w40h:
  s_waitcnt vmcnt(5)
  buffer_load_dwordx4 v[196:199], v60, s[44:47], s52 offen offset:512 nt
  v_dot2_f32_bf16 v27, v204, v4, 0
  v_dot2_f32_bf16 v27, v205, v5, v27
  v_dot2_f32_bf16 v27, v206, v6, v27
  v_dot2_f32_bf16 v27, v207, v7, v27
  v_add_f32_dpp v52, v30, v30 quad_perm:[2,3,0,1] row_mask:0xf bank_mask:0xf
  v_add_f32_dpp v53, v31, v31 quad_perm:[2,3,0,1] row_mask:0xf bank_mask:0xf
  v_cndmask_b32 v33, v52, v53, s[54:55]
  s_cbranch_vccz L_w41h
  s_bitcmp0_b32 vcc_lo, 1
  s_cbranch_scc1 L_w41m
  s_waitcnt vmcnt(3)
L_w41m:
  s_waitcnt vmcnt(4)
L_w41h:
  s_waitcnt vmcnt(5)
  buffer_load_dwordx4 v[200:203], v60, s[44:47], s52 offen offset:1024 nt
  v_dot2_f32_bf16 v24, v208, v4, 0
  v_dot2_f32_bf16 v24, v209, v5, v24
  v_dot2_f32_bf16 v24, v210, v6, v24
  v_dot2_f32_bf16 v24, v211, v7, v24
  v_add_f32_dpp v29, v26, v26 row_ror:8 row_mask:0xf bank_mask:0x3
  v_add_f32_dpp v29, v27, v27 row_ror:8 row_mask:0xf bank_mask:0xc
  s_cbranch_vccz L_w42h
  s_bitcmp0_b32 vcc_lo, 1
  s_cbranch_scc1 L_w42m
  s_waitcnt vmcnt(3)
L_w42m:
  s_waitcnt vmcnt(4)
L_w42h:
  s_waitcnt vmcnt(5)
  buffer_load_dwordx4 v[204:207], v60, s[44:47], s52 offen offset:1536 nt
  v_dot2_f32_bf16 v25, v212, v4, 0
  v_dot2_f32_bf16 v25, v213, v5, v25
  v_dot2_f32_bf16 v25, v214, v6, v25
  v_dot2_f32_bf16 v25, v215, v7, v25
  v_add_f32_dpp v30, v28, v28 row_shl:4 row_mask:0xf bank_mask:0x5
  v_add_f32_dpp v30, v29, v29 row_shr:4 row_mask:0xf bank_mask:0xa
  v_add_f32_dpp v52, v32, v32 quad_perm:[1,0,3,2] row_mask:0xf bank_mask:0xf
  v_add_f32_dpp v53, v33, v33 quad_perm:[1,0,3,2] row_mask:0xf bank_mask:0xf
  v_cndmask_b32 v52, v52, v53, s[56:57]
  v_cvt_pk_bf16_f32 v52, v52, v52
  v_lshlrev_b32 v52, 16, v52
  v_mul_f32 v52, 0x3db504f3, v52
  v_cvt_pk_bf16_f32 v52, v52, v52
  v_lshlrev_b32 v44, 16, v52
  s_cbranch_vccz L_w43h
  s_bitcmp0_b32 vcc_lo, 1
  s_cbranch_scc1 L_w43m
  s_waitcnt vmcnt(3)
L_w43m:
  s_waitcnt vmcnt(4)
L_w43h:
  s_waitcnt vmcnt(5)
  buffer_load_dwordx4 v[208:211], v60, s[44:47], s52 offen offset:2048 nt
  v_dot2_f32_bf16 v26, v216, v4, 0
  v_dot2_f32_bf16 v26, v217, v5, v26
  v_dot2_f32_bf16 v26, v218, v6, v26
  v_dot2_f32_bf16 v26, v219, v7, v26
  v_add_f32_dpp v28, v24, v24 row_ror:8 row_mask:0xf bank_mask:0x3
  v_add_f32_dpp v28, v25, v25 row_ror:8 row_mask:0xf bank_mask:0xc
  s_cbranch_vccz L_w44h
  s_bitcmp0_b32 vcc_lo, 1
  s_cbranch_scc1 L_w44m
  s_waitcnt vmcnt(3)
L_w44m:
  s_waitcnt vmcnt(4)
L_w44h:
  s_waitcnt vmcnt(5)
  buffer_load_dwordx4 v[212:215], v60, s[44:47], s52 offen offset:2560 nt
  v_dot2_f32_bf16 v27, v220, v4, 0
  v_dot2_f32_bf16 v27, v221, v5, v27
  v_dot2_f32_bf16 v27, v222, v6, v27
  v_dot2_f32_bf16 v27, v223, v7, v27
  s_cbranch_vccz L_w45h
  s_bitcmp0_b32 vcc_lo, 1
  s_cbranch_scc1 L_w45m
  s_waitcnt vmcnt(3)
L_w45m:
  s_waitcnt vmcnt(4)
L_w45h:
  s_waitcnt vmcnt(5)
  buffer_load_dwordx4 v[216:219], v60, s[44:47], s52 offen offset:3072 nt
  v_dot2_f32_bf16 v24, v224, v4, 0
  v_dot2_f32_bf16 v24, v225, v5, v24
  v_dot2_f32_bf16 v24, v226, v6, v24
  v_dot2_f32_bf16 v24, v227, v7, v24
  v_add_f32_dpp v29, v26, v26 row_ror:8 row_mask:0xf bank_mask:0x3
  v_add_f32_dpp v29, v27, v27 row_ror:8 row_mask:0xf bank_mask:0xc
  s_cbranch_vccz L_w46h
  s_bitcmp0_b32 vcc_lo, 1
  s_cbranch_scc1 L_w46m
  s_waitcnt vmcnt(3)
L_w46m:
  s_waitcnt vmcnt(4)
L_w46h:
  s_waitcnt vmcnt(5)
  buffer_load_dwordx4 v[220:223], v60, s[44:47], s52 offen offset:3584 nt
  v_dot2_f32_bf16 v25, v228, v4, 0
  v_dot2_f32_bf16 v25, v229, v5, v25
  v_dot2_f32_bf16 v25, v230, v6, v25
  v_dot2_f32_bf16 v25, v231, v7, v25
  v_add_f32_dpp v31, v28, v28 row_shl:4 row_mask:0xf bank_mask:0x5
  v_add_f32_dpp v31, v29, v29 row_shr:4 row_mask:0xf bank_mask:0xa
  s_cbranch_vccz L_w47h
  s_bitcmp0_b32 vcc_lo, 1
  s_cbranch_scc1 L_w47m
  s_waitcnt vmcnt(3)
L_w47m:
  s_waitcnt vmcnt(4)
L_w47h:
  s_waitcnt vmcnt(5)
  s_add_u32 s52, s52, 0x4000
  buffer_load_dwordx4 v[224:227], v60, s[44:47], s52 offen offset:0 nt
  s_waitcnt lgkmcnt(0)
  v_readfirstlane_b32 s66, v58
  v_readfirstlane_b32 s70, v59
  s_and_b32 s66, s66, s72
  s_cmp_eq_u32 s71, 0
  s_cbranch_scc1 L_w48
  s_cmp_lt_u32 s68, 7
  s_cselect_b32 s70, 5, 4
  s_cmp_lt_u32 s68, 1
  s_cselect_b32 s70, 7, s70
  v_mov_b32 v59, s70
  ds_write_b32 v57, v59 offset:5196
L_w48:
  s_cmp_eq_u32 s70, 0
  s_cselect_b32 s70, 1, s70
  s_and_b32 s84, s70, 3
  v_readfirstlane_b32 s69, v51
  s_lshr_b32 s70, s84, 1
  s_cmp_eq_u32 s69, 3
  s_cselect_b32 vcc_lo, s70, s84
  s_lshl_b32 s70, s84, 1
  s_or_b32 s70, s70, 1
  s_and_b32 s70, s70, 3
  s_cmp_eq_u32 s69, 0
  s_cselect_b32 vcc_lo, s70, vcc_lo
  v_dot2_f32_bf16 v26, v232, v4, 0
  v_dot2_f32_bf16 v26, v233, v5, v26
  v_dot2_f32_bf16 v26, v234, v6, v26
  v_dot2_f32_bf16 v26, v235, v7, v26
  v_add_f32_dpp v28, v24, v24 row_ror:8 row_mask:0xf bank_mask:0x3
  v_add_f32_dpp v28, v25, v25 row_ror:8 row_mask:0xf bank_mask:0xc
  s_cbranch_vccz L_w49h
  s_bitcmp0_b32 vcc_lo, 1
  s_cbranch_scc1 L_w49m
  s_waitcnt vmcnt(3)
L_w49m:
  s_waitcnt vmcnt(4)
L_w49h:
  s_waitcnt vmcnt(5)
  buffer_load_dwordx4 v[228:231], v60, s[44:47], s52 offen offset:512 nt
  v_dot2_f32_bf16 v27, v236, v4, 0
  v_dot2_f32_bf16 v27, v237, v5, v27
  v_dot2_f32_bf16 v27, v238, v6, v27
  v_dot2_f32_bf16 v27, v239, v7, v27
  v_add_f32_dpp v52, v30, v30 quad_perm:[2,3,0,1] row_mask:0xf bank_mask:0xf
  v_add_f32_dpp v53, v31, v31 quad_perm:[2,3,0,1] row_mask:0xf bank_mask:0xf
  v_cndmask_b32 v32, v52, v53, s[54:55]
  s_cbranch_vccz L_w50h
  s_bitcmp0_b32 vcc_lo, 1
  s_cbranch_scc1 L_w50m
  s_waitcnt vmcnt(3)
L_w50m:
  s_waitcnt vmcnt(4)
L_w50h:
  s_waitcnt vmcnt(5)
  buffer_load_dwordx4 v[232:235], v60, s[44:47], s52 offen offset:1024 nt
  v_dot2_f32_bf16 v24, v240, v4, 0
  v_dot2_f32_bf16 v24, v241, v5, v24
  v_dot2_f32_bf16 v24, v242, v6, v24
  v_dot2_f32_bf16 v24, v243, v7, v24
  v_add_f32_dpp v29, v26, v26 row_ror:8 row_mask:0xf bank_mask:0x3
  v_add_f32_dpp v29, v27, v27 row_ror:8 row_mask:0xf bank_mask:0xc
  s_cbranch_vccz L_w51h
  s_bitcmp0_b32 vcc_lo, 1
  s_cbranch_scc1 L_w51m
  s_waitcnt vmcnt(3)
L_w51m:
  s_waitcnt vmcnt(4)
L_w51h:
  s_waitcnt vmcnt(5)
  buffer_load_dwordx4 v[236:239], v60, s[44:47], s52 offen offset:1536 nt
  v_dot2_f32_bf16 v25, v244, v4, 0
  v_dot2_f32_bf16 v25, v245, v5, v25
  v_dot2_f32_bf16 v25, v246, v6, v25
  v_dot2_f32_bf16 v25, v247, v7, v25
  v_add_f32_dpp v30, v28, v28 row_shl:4 row_mask:0xf bank_mask:0x5
  v_add_f32_dpp v30, v29, v29 row_shr:4 row_mask:0xf bank_mask:0xa
  s_cbranch_vccz L_w52h
  s_bitcmp0_b32 vcc_lo, 1
  s_cbranch_scc1 L_w52m
  s_waitcnt vmcnt(3)
L_w52m:
  s_waitcnt vmcnt(4)
L_w52h:
  s_waitcnt vmcnt(5)
  buffer_load_dwordx4 v[240:243], v60, s[44:47], s52 offen offset:2048 nt
  v_dot2_f32_bf16 v26, v248, v4, 0
  v_dot2_f32_bf16 v26, v249, v5, v26
  v_dot2_f32_bf16 v26, v250, v6, v26
  v_dot2_f32_bf16 v26, v251, v7, v26
  v_add_f32_dpp v28, v24, v24 row_ror:8 row_mask:0xf bank_mask:0x3
  v_add_f32_dpp v28, v25, v25 row_ror:8 row_mask:0xf bank_mask:0xc
  s_cbranch_vccz L_w53h
  s_bitcmp0_b32 vcc_lo, 1
  s_cbranch_scc1 L_w53m
  s_waitcnt vmcnt(3)
L_w53m:
  s_waitcnt vmcnt(4)
L_w53h:
  s_waitcnt vmcnt(5)
  buffer_load_dwordx4 v[244:247], v60, s[44:47], s52 offen offset:2560 nt
  v_dot2_f32_bf16 v27, v252, v4, 0
  v_dot2_f32_bf16 v27, v253, v5, v27
  v_dot2_f32_bf16 v27, v254, v6, v27
  v_dot2_f32_bf16 v27, v255, v7, v27
  s_cbranch_vccz L_w54h
  s_bitcmp0_b32 vcc_lo, 1
  s_cbranch_scc1 L_w54m
  s_waitcnt vmcnt(3)
L_w54m:
  s_waitcnt vmcnt(4)
L_w54h:
  s_waitcnt vmcnt(5)
  buffer_load_dwordx4 v[248:251], v60, s[44:47], s52 offen offset:3072 nt
  s_add_u32 s53, s53, 1
  s_cmp_lt_u32 s53, 4
  s_cbranch_scc1 L_kloop
  v_dot2_f32_bf16 v24, v64, v4, 0
  v_dot2_f32_bf16 v24, v65, v5, v24
  v_dot2_f32_bf16 v24, v66, v6, v24
  v_dot2_f32_bf16 v24, v67, v7, v24
  v_add_f32_dpp v29, v26, v26 row_ror:8 row_mask:0xf bank_mask:0x3
  v_add_f32_dpp v29, v27, v27 row_ror:8 row_mask:0xf bank_mask:0xc
  v_dot2_f32_bf16 v25, v68, v4, 0
  v_dot2_f32_bf16 v25, v69, v5, v25
  v_dot2_f32_bf16 v25, v70, v6, v25
  v_dot2_f32_bf16 v25, v71, v7, v25
  v_add_f32_dpp v31, v28, v28 row_shl:4 row_mask:0xf bank_mask:0x5
  v_add_f32_dpp v31, v29, v29 row_shr:4 row_mask:0xf bank_mask:0xa
  v_dot2_f32_bf16 v26, v72, v4, 0
  v_dot2_f32_bf16 v26, v73, v5, v26
  v_dot2_f32_bf16 v26, v74, v6, v26
  v_dot2_f32_bf16 v26, v75, v7, v26
  v_add_f32_dpp v28, v24, v24 row_ror:8 row_mask:0xf bank_mask:0x3
  v_add_f32_dpp v28, v25, v25 row_ror:8 row_mask:0xf bank_mask:0xc
  v_dot2_f32_bf16 v27, v76, v4, 0
  v_dot2_f32_bf16 v27, v77, v5, v27
  v_dot2_f32_bf16 v27, v78, v6, v27
  v_dot2_f32_bf16 v27, v79, v7, v27
  v_add_f32_dpp v52, v30, v30 quad_perm:[2,3,0,1] row_mask:0xf bank_mask:0xf
  v_add_f32_dpp v53, v31, v31 quad_perm:[2,3,0,1] row_mask:0xf bank_mask:0xf
  v_cndmask_b32 v33, v52, v53, s[54:55]
  v_dot2_f32_bf16 v24, v80, v4, 0
  v_dot2_f32_bf16 v24, v81, v5, v24
  v_dot2_f32_bf16 v24, v82, v6, v24
  v_dot2_f32_bf16 v24, v83, v7, v24
  v_add_f32_dpp v29, v26, v26 row_ror:8 row_mask:0xf bank_mask:0x3
  v_add_f32_dpp v29, v27, v27 row_ror:8 row_mask:0xf bank_mask:0xc
  s_cbranch_vccz L_w55h
  s_bitcmp0_b32 vcc_lo, 1
  s_cbranch_scc1 L_w55m
  s_waitcnt vmcnt(3)
L_w55m:
  s_waitcnt vmcnt(4)
L_w55h:
  s_waitcnt vmcnt(5)
  buffer_load_dwordx4 v[252:255], v60, s[44:47], s52 offen offset:3584 nt
  s_mov_b32 vcc_lo, s84
  v_dot2_f32_bf16 v25, v84, v4, 0
  v_dot2_f32_bf16 v25, v85, v5, v25
  v_dot2_f32_bf16 v25, v86, v6, v25
  v_dot2_f32_bf16 v25, v87, v7, v25
  v_add_f32_dpp v30, v28, v28 row_shl:4 row_mask:0xf bank_mask:0x5
  v_add_f32_dpp v30, v29, v29 row_shr:4 row_mask:0xf bank_mask:0xa
  v_add_f32_dpp v52, v32, v32 quad_perm:[1,0,3,2] row_mask:0xf bank_mask:0xf
  v_add_f32_dpp v53, v33, v33 quad_perm:[1,0,3,2] row_mask:0xf bank_mask:0xf
  v_cndmask_b32 v52, v52, v53, s[56:57]
  v_cvt_pk_bf16_f32 v52, v52, v52
  v_lshlrev_b32 v52, 16, v52
  v_mul_f32 v52, 0x3db504f3, v52
  v_cvt_pk_bf16_f32 v52, v52, v52
  v_lshlrev_b32 v45, 16, v52
  v_dot2_f32_bf16 v26, v88, v4, 0
  v_dot2_f32_bf16 v26, v89, v5, v26
  v_dot2_f32_bf16 v26, v90, v6, v26
  v_dot2_f32_bf16 v26, v91, v7, v26
  v_add_f32_dpp v28, v24, v24 row_ror:8 row_mask:0xf bank_mask:0x3
  v_add_f32_dpp v28, v25, v25 row_ror:8 row_mask:0xf bank_mask:0xc
  v_dot2_f32_bf16 v27, v92, v4, 0
  v_dot2_f32_bf16 v27, v93, v5, v27
  v_dot2_f32_bf16 v27, v94, v6, v27
  v_dot2_f32_bf16 v27, v95, v7, v27
  v_dot2_f32_bf16 v24, v96, v4, 0
  v_dot2_f32_bf16 v24, v97, v5, v24
  v_dot2_f32_bf16 v24, v98, v6, v24
  v_dot2_f32_bf16 v24, v99, v7, v24
  v_add_f32_dpp v29, v26, v26 row_ror:8 row_mask:0xf bank_mask:0x3
  v_add_f32_dpp v29, v27, v27 row_ror:8 row_mask:0xf bank_mask:0xc
  v_dot2_f32_bf16 v25, v100, v4, 0
  v_dot2_f32_bf16 v25, v101, v5, v25
  v_dot2_f32_bf16 v25, v102, v6, v25
  v_dot2_f32_bf16 v25, v103, v7, v25
  v_add_f32_dpp v31, v28, v28 row_shl:4 row_mask:0xf bank_mask:0x5
  v_add_f32_dpp v31, v29, v29 row_shr:4 row_mask:0xf bank_mask:0xa
  s_cbranch_vccz L_w56h
  s_bitcmp0_b32 vcc_lo, 1
  s_cbranch_scc1 L_w56m
  s_waitcnt vmcnt(3)
L_w56m:
  s_waitcnt vmcnt(4)
L_w56h:
  s_waitcnt vmcnt(5)
  s_add_u32 s52, s52, 0xc000
  buffer_load_dwordx4 v[64:67], v60, s[44:47], s52 offen offset:0 nt
  s_add_u32 s63, s63, 1
  ds_read_b64 v[58:59], v57 offset:5192
  v_mov_b32 v0, s63
  v_lshlrev_b32 v0, 2, v0
  s_mov_b64 exec, 1
  ds_add_rtn_u32 v51, v0, v56 offset:5376
  s_mov_b64 exec, -1
  s_and_b32 s71, s63, 1
  s_cselect_b32 s71, 0, s66
  s_cmp_eq_u32 s71, 0
  s_cbranch_scc1 L_w57
  s_lshr_b32 s67, s63, 1
  s_and_b32 s69, s67, 3
  s_lshl_b32 s69, s69, 2
  s_lshr_b32 s69, 0x5030, s69
  s_and_b32 s69, s69, 15
  s_bfm_b32 s70, s69, 0
  s_and_b32 s70, s70, s2
  s_add_u32 s68, s69, 3
  s_lshr_b32 s68, s2, s68
  s_lshl_b32 s68, s68, s69
  s_or_b32 s68, s68, s70
  s_mul_i32 s68, s68, 4352
  s_lshl_b32 s69, s63, 2
  s_add_u32 s69, s69, s68
  s_mov_b32 s68, 1
  s_atomic_add s68, s[64:65], s69 glc
L_w57:
  v_dot2_f32_bf16 v26, v104, v4, 0
  v_dot2_f32_bf16 v26, v105, v5, v26
  v_dot2_f32_bf16 v26, v106, v6, v26
  v_dot2_f32_bf16 v26, v107, v7, v26
  v_add_f32_dpp v28, v24, v24 row_ror:8 row_mask:0xf bank_mask:0x3
  v_add_f32_dpp v28, v25, v25 row_ror:8 row_mask:0xf bank_mask:0xc
  v_dot2_f32_bf16 v27, v108, v4, 0
  v_dot2_f32_bf16 v27, v109, v5, v27
  v_dot2_f32_bf16 v27, v110, v6, v27
  v_dot2_f32_bf16 v27, v111, v7, v27
  v_add_f32_dpp v52, v30, v30 quad_perm:[2,3,0,1] row_mask:0xf bank_mask:0xf
  v_add_f32_dpp v53, v31, v31 quad_perm:[2,3,0,1] row_mask:0xf bank_mask:0xf
  v_cndmask_b32 v32, v52, v53, s[54:55]
  v_dot2_f32_bf16 v24, v112, v4, 0
  v_dot2_f32_bf16 v24, v113, v5, v24
  v_dot2_f32_bf16 v24, v114, v6, v24
  v_dot2_f32_bf16 v24, v115, v7, v24
  v_add_f32_dpp v29, v26, v26 row_ror:8 row_mask:0xf bank_mask:0x3
  v_add_f32_dpp v29, v27, v27 row_ror:8 row_mask:0xf bank_mask:0xc
  v_dot2_f32_bf16 v25, v116, v4, 0
  v_dot2_f32_bf16 v25, v117, v5, v25
  v_dot2_f32_bf16 v25, v118, v6, v25
  v_dot2_f32_bf16 v25, v119, v7, v25
  v_add_f32_dpp v30, v28, v28 row_shl:4 row_mask:0xf bank_mask:0x5
  v_add_f32_dpp v30, v29, v29 row_shr:4 row_mask:0xf bank_mask:0xa
  v_dot2_f32_bf16 v26, v120, v4, 0
  v_dot2_f32_bf16 v26, v121, v5, v26
  v_dot2_f32_bf16 v26, v122, v6, v26
  v_dot2_f32_bf16 v26, v123, v7, v26
  v_add_f32_dpp v28, v24, v24 row_ror:8 row_mask:0xf bank_mask:0x3
  v_add_f32_dpp v28, v25, v25 row_ror:8 row_mask:0xf bank_mask:0xc
  s_cbranch_vccz L_w58h
  s_bitcmp0_b32 vcc_lo, 1
  s_cbranch_scc1 L_w58m
  s_waitcnt vmcnt(3)
L_w58m:
  s_waitcnt vmcnt(4)
L_w58h:
  s_waitcnt vmcnt(5)
  buffer_load_dwordx4 v[68:71], v60, s[44:47], s52 offen offset:512 nt
  v_dot2_f32_bf16 v27, v124, v4, 0
  v_dot2_f32_bf16 v27, v125, v5, v27
  v_dot2_f32_bf16 v27, v126, v6, v27
  v_dot2_f32_bf16 v27, v127, v7, v27
  v_dot2_f32_bf16 v24, v128, v4, 0
  v_dot2_f32_bf16 v24, v129, v5, v24
  v_dot2_f32_bf16 v24, v130, v6, v24
  v_dot2_f32_bf16 v24, v131, v7, v24
  v_add_f32_dpp v29, v26, v26 row_ror:8 row_mask:0xf bank_mask:0x3
  v_add_f32_dpp v29, v27, v27 row_ror:8 row_mask:0xf bank_mask:0xc
  v_dot2_f32_bf16 v25, v132, v4, 0
  v_dot2_f32_bf16 v25, v133, v5, v25
  v_dot2_f32_bf16 v25, v134, v6, v25
  v_dot2_f32_bf16 v25, v135, v7, v25
  v_add_f32_dpp v31, v28, v28 row_shl:4 row_mask:0xf bank_mask:0x5
  v_add_f32_dpp v31, v29, v29 row_shr:4 row_mask:0xf bank_mask:0xa
  v_dot2_f32_bf16 v26, v136, v4, 0
  v_dot2_f32_bf16 v26, v137, v5, v26
  v_dot2_f32_bf16 v26, v138, v6, v26
  v_dot2_f32_bf16 v26, v139, v7, v26
  v_add_f32_dpp v28, v24, v24 row_ror:8 row_mask:0xf bank_mask:0x3
  v_add_f32_dpp v28, v25, v25 row_ror:8 row_mask:0xf bank_mask:0xc
  v_dot2_f32_bf16 v27, v140, v4, 0
  v_dot2_f32_bf16 v27, v141, v5, v27
  v_dot2_f32_bf16 v27, v142, v6, v27
  v_dot2_f32_bf16 v27, v143, v7, v27
  v_add_f32_dpp v52, v30, v30 quad_perm:[2,3,0,1] row_mask:0xf bank_mask:0xf
  v_add_f32_dpp v53, v31, v31 quad_perm:[2,3,0,1] row_mask:0xf bank_mask:0xf
  v_cndmask_b32 v33, v52, v53, s[54:55]
  s_cbranch_vccz L_w59h
  s_bitcmp0_b32 vcc_lo, 1
  s_cbranch_scc1 L_w59m
  s_waitcnt vmcnt(3)
L_w59m:
  s_waitcnt vmcnt(4)
L_w59h:
  s_waitcnt vmcnt(5)
  buffer_load_dwordx4 v[72:75], v60, s[44:47], s52 offen offset:1024 nt
  v_dot2_f32_bf16 v24, v144, v4, 0
  v_dot2_f32_bf16 v24, v145, v5, v24
  v_dot2_f32_bf16 v24, v146, v6, v24
  v_dot2_f32_bf16 v24, v147, v7, v24
  v_add_f32_dpp v29, v26, v26 row_ror:8 row_mask:0xf bank_mask:0x3
  v_add_f32_dpp v29, v27, v27 row_ror:8 row_mask:0xf bank_mask:0xc
  v_dot2_f32_bf16 v25, v148, v4, 0
  v_dot2_f32_bf16 v25, v149, v5, v25
  v_dot2_f32_bf16 v25, v150, v6, v25
  v_dot2_f32_bf16 v25, v151, v7, v25
  v_add_f32_dpp v30, v28, v28 row_shl:4 row_mask:0xf bank_mask:0x5
  v_add_f32_dpp v30, v29, v29 row_shr:4 row_mask:0xf bank_mask:0xa
  v_add_f32_dpp v52, v32, v32 quad_perm:[1,0,3,2] row_mask:0xf bank_mask:0xf
  v_add_f32_dpp v53, v33, v33 quad_perm:[1,0,3,2] row_mask:0xf bank_mask:0xf
  v_cndmask_b32 v52, v52, v53, s[56:57]
  v_cvt_pk_bf16_f32 v52, v52, v52
  v_lshlrev_b32 v52, 16, v52
  v_mul_f32 v52, 0x3db504f3, v52
  v_cvt_pk_bf16_f32 v52, v52, v52
  v_lshlrev_b32 v46, 16, v52
  v_dot2_f32_bf16 v26, v152, v4, 0
  v_dot2_f32_bf16 v26, v153, v5, v26
  v_dot2_f32_bf16 v26, v154, v6, v26
  v_dot2_f32_bf16 v26, v155, v7, v26
  v_add_f32_dpp v28, v24, v24 row_ror:8 row_mask:0xf bank_mask:0x3
  v_add_f32_dpp v28, v25, v25 row_ror:8 row_mask:0xf bank_mask:0xc
  v_dot2_f32_bf16 v27, v156, v4, 0
  v_dot2_f32_bf16 v27, v157, v5, v27
  v_dot2_f32_bf16 v27, v158, v6, v27
  v_dot2_f32_bf16 v27, v159, v7, v27
  v_dot2_f32_bf16 v24, v160, v4, 0
  v_dot2_f32_bf16 v24, v161, v5, v24
  v_dot2_f32_bf16 v24, v162, v6, v24
  v_dot2_f32_bf16 v24, v163, v7, v24
  v_add_f32_dpp v29, v26, v26 row_ror:8 row_mask:0xf bank_mask:0x3
  v_add_f32_dpp v29, v27, v27 row_ror:8 row_mask:0xf bank_mask:0xc
  s_cbranch_vccz L_w60h
  s_bitcmp0_b32 vcc_lo, 1
  s_cbranch_scc1 L_w60m
  s_waitcnt vmcnt(3)
L_w60m:
  s_waitcnt vmcnt(4)
L_w60h:
  s_waitcnt vmcnt(5)
  buffer_load_dwordx4 v[76:79], v60, s[44:47], s52 offen offset:1536 nt
  v_dot2_f32_bf16 v25, v164, v4, 0
  v_dot2_f32_bf16 v25, v165, v5, v25
  v_dot2_f32_bf16 v25, v166, v6, v25
  v_dot2_f32_bf16 v25, v167, v7, v25
  v_add_f32_dpp v31, v28, v28 row_shl:4 row_mask:0xf bank_mask:0x5
  v_add_f32_dpp v31, v29, v29 row_shr:4 row_mask:0xf bank_mask:0xa
  v_dot2_f32_bf16 v26, v168, v4, 0
  v_dot2_f32_bf16 v26, v169, v5, v26
  v_dot2_f32_bf16 v26, v170, v6, v26
  v_dot2_f32_bf16 v26, v171, v7, v26
  v_add_f32_dpp v28, v24, v24 row_ror:8 row_mask:0xf bank_mask:0x3
  v_add_f32_dpp v28, v25, v25 row_ror:8 row_mask:0xf bank_mask:0xc
  v_dot2_f32_bf16 v27, v172, v4, 0
  v_dot2_f32_bf16 v27, v173, v5, v27
  v_dot2_f32_bf16 v27, v174, v6, v27
  v_dot2_f32_bf16 v27, v175, v7, v27
  v_add_f32_dpp v52, v30, v30 quad_perm:[2,3,0,1] row_mask:0xf bank_mask:0xf
  v_add_f32_dpp v53, v31, v31 quad_perm:[2,3,0,1] row_mask:0xf bank_mask:0xf
  v_cndmask_b32 v32, v52, v53, s[54:55]
  v_dot2_f32_bf16 v24, v176, v4, 0
  v_dot2_f32_bf16 v24, v177, v5, v24
  v_dot2_f32_bf16 v24, v178, v6, v24
  v_dot2_f32_bf16 v24, v179, v7, v24
  v_add_f32_dpp v29, v26, v26 row_ror:8 row_mask:0xf bank_mask:0x3
  v_add_f32_dpp v29, v27, v27 row_ror:8 row_mask:0xf bank_mask:0xc
  v_dot2_f32_bf16 v25, v180, v4, 0
  v_dot2_f32_bf16 v25, v181, v5, v25
  v_dot2_f32_bf16 v25, v182, v6, v25
  v_dot2_f32_bf16 v25, v183, v7, v25
  v_add_f32_dpp v30, v28, v28 row_shl:4 row_mask:0xf bank_mask:0x5
  v_add_f32_dpp v30, v29, v29 row_shr:4 row_mask:0xf bank_mask:0xa
  s_cbranch_vccz L_w61h
  s_bitcmp0_b32 vcc_lo, 1
  s_cbranch_scc1 L_w61m
  s_waitcnt vmcnt(3)
L_w61m:
  s_waitcnt vmcnt(4)
L_w61h:
  s_waitcnt vmcnt(5)
  buffer_load_dwordx4 v[80:83], v60, s[44:47], s52 offen offset:2048 nt
  v_dot2_f32_bf16 v26, v184, v4, 0
  v_dot2_f32_bf16 v26, v185, v5, v26
  v_dot2_f32_bf16 v26, v186, v6, v26
  v_dot2_f32_bf16 v26, v187, v7, v26
  v_add_f32_dpp v28, v24, v24 row_ror:8 row_mask:0xf bank_mask:0x3
  v_add_f32_dpp v28, v25, v25 row_ror:8 row_mask:0xf bank_mask:0xc
  v_dot2_f32_bf16 v27, v188, v4, 0
  v_dot2_f32_bf16 v27, v189, v5, v27
  v_dot2_f32_bf16 v27, v190, v6, v27
  v_dot2_f32_bf16 v27, v191, v7, v27
  v_dot2_f32_bf16 v24, v192, v4, 0
  v_dot2_f32_bf16 v24, v193, v5, v24
  v_dot2_f32_bf16 v24, v194, v6, v24
  v_dot2_f32_bf16 v24, v195, v7, v24
  v_add_f32_dpp v29, v26, v26 row_ror:8 row_mask:0xf bank_mask:0x3
  v_add_f32_dpp v29, v27, v27 row_ror:8 row_mask:0xf bank_mask:0xc
  v_dot2_f32_bf16 v25, v196, v4, 0
  v_dot2_f32_bf16 v25, v197, v5, v25
  v_dot2_f32_bf16 v25, v198, v6, v25
  v_dot2_f32_bf16 v25, v199, v7, v25
  v_add_f32_dpp v31, v28, v28 row_shl:4 row_mask:0xf bank_mask:0x5
  v_add_f32_dpp v31, v29, v29 row_shr:4 row_mask:0xf bank_mask:0xa
  v_dot2_f32_bf16 v26, v200, v4, 0
  v_dot2_f32_bf16 v26, v201, v5, v26
  v_dot2_f32_bf16 v26, v202, v6, v26
  v_dot2_f32_bf16 v26, v203, v7, v26
  v_add_f32_dpp v28, v24, v24 row_ror:8 row_mask:0xf bank_mask:0x3
  v_add_f32_dpp v28, v25, v25 row_ror:8 row_mask:0xf bank_mask:0xc
  s_cbranch_vccz L_w62h
  s_bitcmp0_b32 vcc_lo, 1
  s_cbranch_scc1 L_w62m
  s_waitcnt vmcnt(3)
L_w62m:
  s_waitcnt vmcnt(4)
L_w62h:
  s_waitcnt vmcnt(5)
  buffer_load_dwordx4 v[84:87], v60, s[44:47], s52 offen offset:2560 nt
  v_dot2_f32_bf16 v27, v204, v4, 0
  v_dot2_f32_bf16 v27, v205, v5, v27
  v_dot2_f32_bf16 v27, v206, v6, v27
  v_dot2_f32_bf16 v27, v207, v7, v27
  v_add_f32_dpp v52, v30, v30 quad_perm:[2,3,0,1] row_mask:0xf bank_mask:0xf
  v_add_f32_dpp v53, v31, v31 quad_perm:[2,3,0,1] row_mask:0xf bank_mask:0xf
  v_cndmask_b32 v33, v52, v53, s[54:55]
  v_dot2_f32_bf16 v24, v208, v4, 0
  v_dot2_f32_bf16 v24, v209, v5, v24
  v_dot2_f32_bf16 v24, v210, v6, v24
  v_dot2_f32_bf16 v24, v211, v7, v24
  v_add_f32_dpp v29, v26, v26 row_ror:8 row_mask:0xf bank_mask:0x3
  v_add_f32_dpp v29, v27, v27 row_ror:8 row_mask:0xf bank_mask:0xc
  v_dot2_f32_bf16 v25, v212, v4, 0
  v_dot2_f32_bf16 v25, v213, v5, v25
  v_dot2_f32_bf16 v25, v214, v6, v25
  v_dot2_f32_bf16 v25, v215, v7, v25
  v_add_f32_dpp v30, v28, v28 row_shl:4 row_mask:0xf bank_mask:0x5
  v_add_f32_dpp v30, v29, v29 row_shr:4 row_mask:0xf bank_mask:0xa
  v_add_f32_dpp v52, v32, v32 quad_perm:[1,0,3,2] row_mask:0xf bank_mask:0xf
  v_add_f32_dpp v53, v33, v33 quad_perm:[1,0,3,2] row_mask:0xf bank_mask:0xf
  v_cndmask_b32 v52, v52, v53, s[56:57]
  v_cvt_pk_bf16_f32 v52, v52, v52
  v_lshlrev_b32 v52, 16, v52
  v_mul_f32 v52, 0x3db504f3, v52
  v_cvt_pk_bf16_f32 v52, v52, v52
  v_lshlrev_b32 v47, 16, v52
  v_dot2_f32_bf16 v26, v216, v4, 0
  v_dot2_f32_bf16 v26, v217, v5, v26
  v_dot2_f32_bf16 v26, v218, v6, v26
  v_dot2_f32_bf16 v26, v219, v7, v26
  v_add_f32_dpp v28, v24, v24 row_ror:8 row_mask:0xf bank_mask:0x3
  v_add_f32_dpp v28, v25, v25 row_ror:8 row_mask:0xf bank_mask:0xc
  v_dot2_f32_bf16 v27, v220, v4, 0
  v_dot2_f32_bf16 v27, v221, v5, v27
  v_dot2_f32_bf16 v27, v222, v6, v27
  v_dot2_f32_bf16 v27, v223, v7, v27
  s_cbranch_vccz L_w63h
  s_bitcmp0_b32 vcc_lo, 1
  s_cbranch_scc1 L_w63m
  s_waitcnt vmcnt(3)
L_w63m:
  s_waitcnt vmcnt(4)
L_w63h:
  s_waitcnt vmcnt(5)
  buffer_load_dwordx4 v[88:91], v60, s[44:47], s52 offen offset:3072 nt
  v_dot2_f32_bf16 v24, v224, v4, 0
  v_dot2_f32_bf16 v24, v225, v5, v24
  v_dot2_f32_bf16 v24, v226, v6, v24
  v_dot2_f32_bf16 v24, v227, v7, v24
  v_add_f32_dpp v29, v26, v26 row_ror:8 row_mask:0xf bank_mask:0x3
  v_add_f32_dpp v29, v27, v27 row_ror:8 row_mask:0xf bank_mask:0xc
  v_dot2_f32_bf16 v25, v228, v4, 0
  v_dot2_f32_bf16 v25, v229, v5, v25
  v_dot2_f32_bf16 v25, v230, v6, v25
  v_dot2_f32_bf16 v25, v231, v7, v25
  v_add_f32_dpp v31, v28, v28 row_shl:4 row_mask:0xf bank_mask:0x5
  v_add_f32_dpp v31, v29, v29 row_shr:4 row_mask:0xf bank_mask:0xa
  v_dot2_f32_bf16 v26, v232, v4, 0
  v_dot2_f32_bf16 v26, v233, v5, v26
  v_dot2_f32_bf16 v26, v234, v6, v26
  v_dot2_f32_bf16 v26, v235, v7, v26
  v_add_f32_dpp v28, v24, v24 row_ror:8 row_mask:0xf bank_mask:0x3
  v_add_f32_dpp v28, v25, v25 row_ror:8 row_mask:0xf bank_mask:0xc
  v_dot2_f32_bf16 v27, v236, v4, 0
  v_dot2_f32_bf16 v27, v237, v5, v27
  v_dot2_f32_bf16 v27, v238, v6, v27
  v_dot2_f32_bf16 v27, v239, v7, v27
  v_add_f32_dpp v52, v30, v30 quad_perm:[2,3,0,1] row_mask:0xf bank_mask:0xf
  v_add_f32_dpp v53, v31, v31 quad_perm:[2,3,0,1] row_mask:0xf bank_mask:0xf
  v_cndmask_b32 v32, v52, v53, s[54:55]
  v_dot2_f32_bf16 v24, v240, v4, 0
  v_dot2_f32_bf16 v24, v241, v5, v24
  v_dot2_f32_bf16 v24, v242, v6, v24
  v_dot2_f32_bf16 v24, v243, v7, v24
  v_add_f32_dpp v29, v26, v26 row_ror:8 row_mask:0xf bank_mask:0x3
  v_add_f32_dpp v29, v27, v27 row_ror:8 row_mask:0xf bank_mask:0xc
  s_cbranch_vccz L_w64h
  s_bitcmp0_b32 vcc_lo, 1
  s_cbranch_scc1 L_w64m
  s_waitcnt vmcnt(3)
L_w64m:
  s_waitcnt vmcnt(4)
L_w64h:
  s_waitcnt vmcnt(5)
  buffer_load_dwordx4 v[92:95], v60, s[44:47], s52 offen offset:3584 nt
  v_dot2_f32_bf16 v25, v244, v4, 0
  v_dot2_f32_bf16 v25, v245, v5, v25
  v_dot2_f32_bf16 v25, v246, v6, v25
  v_dot2_f32_bf16 v25, v247, v7, v25
  v_add_f32_dpp v30, v28, v28 row_shl:4 row_mask:0xf bank_mask:0x5
  v_add_f32_dpp v30, v29, v29 row_shr:4 row_mask:0xf bank_mask:0xa
  v_dot2_f32_bf16 v26, v248, v4, 0
  v_dot2_f32_bf16 v26, v249, v5, v26
  v_dot2_f32_bf16 v26, v250, v6, v26
  v_dot2_f32_bf16 v26, v251, v7, v26
  v_add_f32_dpp v28, v24, v24 row_ror:8 row_mask:0xf bank_mask:0x3
  v_add_f32_dpp v28, v25, v25 row_ror:8 row_mask:0xf bank_mask:0xc
  v_dot2_f32_bf16 v27, v252, v4, 0
  v_dot2_f32_bf16 v27, v253, v5, v27
  v_dot2_f32_bf16 v27, v254, v6, v27
  v_dot2_f32_bf16 v27, v255, v7, v27
  v_dot2_f32_bf16 v24, v64, v4, 0
  v_dot2_f32_bf16 v24, v65, v5, v24
  v_dot2_f32_bf16 v24, v66, v6, v24
  v_dot2_f32_bf16 v24, v67, v7, v24
  v_add_f32_dpp v29, v26, v26 row_ror:8 row_mask:0xf bank_mask:0x3
  v_add_f32_dpp v29, v27, v27 row_ror:8 row_mask:0xf bank_mask:0xc
  v_dot2_f32_bf16 v25, v68, v4, 0
  v_dot2_f32_bf16 v25, v69, v5, v25
  v_dot2_f32_bf16 v25, v70, v6, v25
  v_dot2_f32_bf16 v25, v71, v7, v25
  v_add_f32_dpp v31, v28, v28 row_shl:4 row_mask:0xf bank_mask:0x5
  v_add_f32_dpp v31, v29, v29 row_shr:4 row_mask:0xf bank_mask:0xa
  s_cbranch_vccz L_w65h
  s_bitcmp0_b32 vcc_lo, 1
  s_cbranch_scc1 L_w65m
  s_waitcnt vmcnt(3)
L_w65m:
  s_waitcnt vmcnt(4)
L_w65h:
  s_waitcnt vmcnt(5)
  s_add_u32 s52, s52, 0x4000
  buffer_load_dwordx4 v[96:99], v60, s[44:47], s52 offen offset:0 nt
  s_waitcnt lgkmcnt(0)
  v_readfirstlane_b32 s66, v58
  v_readfirstlane_b32 s70, v59
  s_and_b32 s66, s66, s72
  s_cmp_eq_u32 s71, 0
  s_cbranch_scc1 L_w66
  s_cmp_lt_u32 s68, 7
  s_cselect_b32 s70, 5, 4
  s_cmp_lt_u32 s68, 1
  s_cselect_b32 s70, 7, s70
  v_mov_b32 v59, s70
  ds_write_b32 v57, v59 offset:5196
L_w66:
  s_cmp_eq_u32 s70, 0
  s_cselect_b32 s70, 1, s70
  s_and_b32 s84, s70, 3
  v_readfirstlane_b32 s69, v51
  s_lshr_b32 s70, s84, 1
  s_cmp_eq_u32 s69, 3
  s_cselect_b32 vcc_lo, s70, s84
  s_lshl_b32 s70, s84, 1
  s_or_b32 s70, s70, 1
  s_and_b32 s70, s70, 3
  s_cmp_eq_u32 s69, 0
  s_cselect_b32 vcc_lo, s70, vcc_lo
  v_dot2_f32_bf16 v26, v72, v4, 0
  v_dot2_f32_bf16 v26, v73, v5, v26
  v_dot2_f32_bf16 v26, v74, v6, v26
  v_dot2_f32_bf16 v26, v75, v7, v26
  v_add_f32_dpp v28, v24, v24 row_ror:8 row_mask:0xf bank_mask:0x3
  v_add_f32_dpp v28, v25, v25 row_ror:8 row_mask:0xf bank_mask:0xc
  s_cbranch_vccz L_w67h
  s_bitcmp0_b32 vcc_lo, 1
  s_cbranch_scc1 L_w67m
  s_waitcnt vmcnt(3)
L_w67m:
  s_waitcnt vmcnt(4)
L_w67h:
  s_waitcnt vmcnt(5)
  buffer_load_dwordx4 v[100:103], v60, s[44:47], s52 offen offset:512 nt
  v_dot2_f32_bf16 v27, v76, v4, 0
  v_dot2_f32_bf16 v27, v77, v5, v27
  v_dot2_f32_bf16 v27, v78, v6, v27
  v_dot2_f32_bf16 v27, v79, v7, v27
  v_add_f32_dpp v52, v30, v30 quad_perm:[2,3,0,1] row_mask:0xf bank_mask:0xf
  v_add_f32_dpp v53, v31, v31 quad_perm:[2,3,0,1] row_mask:0xf bank_mask:0xf
  v_cndmask_b32 v33, v52, v53, s[54:55]
  s_cbranch_vccz L_w68h
  s_bitcmp0_b32 vcc_lo, 1
  s_cbranch_scc1 L_w68m
  s_waitcnt vmcnt(3)
L_w68m:
  s_waitcnt vmcnt(4)
L_w68h:
  s_waitcnt vmcnt(5)
  buffer_load_dwordx4 v[104:107], v60, s[44:47], s52 offen offset:1024 nt
  v_dot2_f32_bf16 v24, v80, v4, 0
  v_dot2_f32_bf16 v24, v81, v5, v24
  v_dot2_f32_bf16 v24, v82, v6, v24
  v_dot2_f32_bf16 v24, v83, v7, v24
  v_add_f32_dpp v29, v26, v26 row_ror:8 row_mask:0xf bank_mask:0x3
  v_add_f32_dpp v29, v27, v27 row_ror:8 row_mask:0xf bank_mask:0xc
  s_cbranch_vccz L_w69h
  s_bitcmp0_b32 vcc_lo, 1
  s_cbranch_scc1 L_w69m
  s_waitcnt vmcnt(3)
L_w69m:
  s_waitcnt vmcnt(4)
L_w69h:
  s_waitcnt vmcnt(5)
  buffer_load_dwordx4 v[108:111], v60, s[44:47], s52 offen offset:1536 nt
  v_dot2_f32_bf16 v25, v84, v4, 0
  v_dot2_f32_bf16 v25, v85, v5, v25
  v_dot2_f32_bf16 v25, v86, v6, v25
  v_dot2_f32_bf16 v25, v87, v7, v25
  v_add_f32_dpp v30, v28, v28 row_shl:4 row_mask:0xf bank_mask:0x5
  v_add_f32_dpp v30, v29, v29 row_shr:4 row_mask:0xf bank_mask:0xa
  v_add_f32_dpp v52, v32, v32 quad_perm:[1,0,3,2] row_mask:0xf bank_mask:0xf
  v_add_f32_dpp v53, v33, v33 quad_perm:[1,0,3,2] row_mask:0xf bank_mask:0xf
  v_cndmask_b32 v52, v52, v53, s[56:57]
  v_cvt_pk_bf16_f32 v52, v52, v52
  v_lshlrev_b32 v52, 16, v52
  v_mul_f32 v52, 0x3db504f3, v52
  v_cvt_pk_bf16_f32 v52, v52, v52
  v_lshlrev_b32 v48, 16, v52
  s_cbranch_vccz L_w70h
  s_bitcmp0_b32 vcc_lo, 1
  s_cbranch_scc1 L_w70m
  s_waitcnt vmcnt(3)
L_w70m:
  s_waitcnt vmcnt(4)
L_w70h:
  s_waitcnt vmcnt(5)
  buffer_load_dwordx4 v[112:115], v60, s[44:47], s52 offen offset:2048 nt
  v_dot2_f32_bf16 v26, v88, v4, 0
  v_dot2_f32_bf16 v26, v89, v5, v26
  v_dot2_f32_bf16 v26, v90, v6, v26
  v_dot2_f32_bf16 v26, v91, v7, v26
  v_add_f32_dpp v28, v24, v24 row_ror:8 row_mask:0xf bank_mask:0x3
  v_add_f32_dpp v28, v25, v25 row_ror:8 row_mask:0xf bank_mask:0xc
  s_cbranch_vccz L_w71h
  s_bitcmp0_b32 vcc_lo, 1
  s_cbranch_scc1 L_w71m
  s_waitcnt vmcnt(3)
L_w71m:
  s_waitcnt vmcnt(4)
L_w71h:
  s_waitcnt vmcnt(5)
  buffer_load_dwordx4 v[116:119], v60, s[44:47], s52 offen offset:2560 nt
  v_dot2_f32_bf16 v27, v92, v4, 0
  v_dot2_f32_bf16 v27, v93, v5, v27
  v_dot2_f32_bf16 v27, v94, v6, v27
  v_dot2_f32_bf16 v27, v95, v7, v27
  s_cbranch_vccz L_w72h
  s_bitcmp0_b32 vcc_lo, 1
  s_cbranch_scc1 L_w72m
  s_waitcnt vmcnt(3)
L_w72m:
  s_waitcnt vmcnt(4)
L_w72h:
  s_waitcnt vmcnt(5)
  buffer_load_dwordx4 v[120:123], v60, s[44:47], s52 offen offset:3072 nt
  v_dot2_f32_bf16 v24, v96, v4, 0
  v_dot2_f32_bf16 v24, v97, v5, v24
  v_dot2_f32_bf16 v24, v98, v6, v24
  v_dot2_f32_bf16 v24, v99, v7, v24
  v_add_f32_dpp v29, v26, v26 row_ror:8 row_mask:0xf bank_mask:0x3
  v_add_f32_dpp v29, v27, v27 row_ror:8 row_mask:0xf bank_mask:0xc
  s_cbranch_vccz L_w73h
  s_bitcmp0_b32 vcc_lo, 1
  s_cbranch_scc1 L_w73m
  s_waitcnt vmcnt(3)
L_w73m:
  s_waitcnt vmcnt(4)
L_w73h:
  s_waitcnt vmcnt(5)
  buffer_load_dwordx4 v[124:127], v60, s[44:47], s52 offen offset:3584 nt
  s_mov_b32 vcc_lo, s84
  v_dot2_f32_bf16 v25, v100, v4, 0
  v_dot2_f32_bf16 v25, v101, v5, v25
  v_dot2_f32_bf16 v25, v102, v6, v25
  v_dot2_f32_bf16 v25, v103, v7, v25
  v_add_f32_dpp v31, v28, v28 row_shl:4 row_mask:0xf bank_mask:0x5
  v_add_f32_dpp v31, v29, v29 row_shr:4 row_mask:0xf bank_mask:0xa
  s_cbranch_vccz L_w74h
  s_bitcmp0_b32 vcc_lo, 1
  s_cbranch_scc1 L_w74m
  s_waitcnt vmcnt(3)
L_w74m:
  s_waitcnt vmcnt(4)
L_w74h:
  s_waitcnt vmcnt(5)
  s_mov_b32 s52, 0
  buffer_load_dwordx4 v[128:131], v60, s[48:51], s52 offen offset:0 nt
  s_add_u32 s63, s63, 1
  ds_read_b64 v[58:59], v57 offset:5192
  v_mov_b32 v0, s63
  v_lshlrev_b32 v0, 2, v0
  s_mov_b64 exec, 1
  ds_add_rtn_u32 v51, v0, v56 offset:5376
  s_mov_b64 exec, -1
  s_and_b32 s71, s63, 1
  s_cselect_b32 s71, 0, s66
  s_cmp_eq_u32 s71, 0
  s_cbranch_scc1 L_w75
  s_lshr_b32 s67, s63, 1
  s_and_b32 s69, s67, 3
  s_lshl_b32 s69, s69, 2
  s_lshr_b32 s69, 0x5030, s69
  s_and_b32 s69, s69, 15
  s_bfm_b32 s70, s69, 0
  s_and_b32 s70, s70, s2
  s_add_u32 s68, s69, 3
  s_lshr_b32 s68, s2, s68
  s_lshl_b32 s68, s68, s69
  s_or_b32 s68, s68, s70
  s_mul_i32 s68, s68, 4352
  s_lshl_b32 s69, s63, 2
  s_add_u32 s69, s69, s68
  s_mov_b32 s68, 1
  s_atomic_add s68, s[64:65], s69 glc
L_w75:
  v_dot2_f32_bf16 v26, v104, v4, 0
  v_dot2_f32_bf16 v26, v105, v5, v26
  v_dot2_f32_bf16 v26, v106, v6, v26
  v_dot2_f32_bf16 v26, v107, v7, v26
  v_add_f32_dpp v28, v24, v24 row_ror:8 row_mask:0xf bank_mask:0x3
  v_add_f32_dpp v28, v25, v25 row_ror:8 row_mask:0xf bank_mask:0xc
  s_cbranch_vccz L_w76h
  s_bitcmp0_b32 vcc_lo, 1
  s_cbranch_scc1 L_w76m
  s_waitcnt vmcnt(3)
L_w76m:
  s_waitcnt vmcnt(4)
L_w76h:
  s_waitcnt vmcnt(5)
  buffer_load_dwordx4 v[132:135], v60, s[48:51], s52 offen offset:512 nt
  v_dot2_f32_bf16 v27, v108, v4, 0
  v_dot2_f32_bf16 v27, v109, v5, v27
  v_dot2_f32_bf16 v27, v110, v6, v27
  v_dot2_f32_bf16 v27, v111, v7, v27
  v_add_f32_dpp v52, v30, v30 quad_perm:[2,3,0,1] row_mask:0xf bank_mask:0xf
  v_add_f32_dpp v53, v31, v31 quad_perm:[2,3,0,1] row_mask:0xf bank_mask:0xf
  v_cndmask_b32 v32, v52, v53, s[54:55]
  s_cbranch_vccz L_w77h
  s_bitcmp0_b32 vcc_lo, 1
  s_cbranch_scc1 L_w77m
  s_waitcnt vmcnt(3)
L_w77m:
  s_waitcnt vmcnt(4)
L_w77h:
  s_waitcnt vmcnt(5)
  buffer_load_dwordx4 v[136:139], v60, s[48:51], s52 offen offset:1024 nt
  v_dot2_f32_bf16 v24, v112, v4, 0
  v_dot2_f32_bf16 v24, v113, v5, v24
  v_dot2_f32_bf16 v24, v114, v6, v24
  v_dot2_f32_bf16 v24, v115, v7, v24
  v_add_f32_dpp v29, v26, v26 row_ror:8 row_mask:0xf bank_mask:0x3
  v_add_f32_dpp v29, v27, v27 row_ror:8 row_mask:0xf bank_mask:0xc
  s_cbranch_vccz L_w78h
  s_bitcmp0_b32 vcc_lo, 1
  s_cbranch_scc1 L_w78m
  s_waitcnt vmcnt(3)
L_w78m:
  s_waitcnt vmcnt(4)
L_w78h:
  s_waitcnt vmcnt(5)
  buffer_load_dwordx4 v[140:143], v60, s[48:51], s52 offen offset:1536 nt
  v_dot2_f32_bf16 v25, v116, v4, 0
  v_dot2_f32_bf16 v25, v117, v5, v25
  v_dot2_f32_bf16 v25, v118, v6, v25
  v_dot2_f32_bf16 v25, v119, v7, v25
  v_add_f32_dpp v30, v28, v28 row_shl:4 row_mask:0xf bank_mask:0x5
  v_add_f32_dpp v30, v29, v29 row_shr:4 row_mask:0xf bank_mask:0xa
  s_cbranch_vccz L_w79h
  s_bitcmp0_b32 vcc_lo, 1
  s_cbranch_scc1 L_w79m
  s_waitcnt vmcnt(3)
L_w79m:
  s_waitcnt vmcnt(4)
L_w79h:
  s_waitcnt vmcnt(5)
  buffer_load_dwordx4 v[144:147], v60, s[48:51], s52 offen offset:2048 nt
  v_dot2_f32_bf16 v26, v120, v4, 0
  v_dot2_f32_bf16 v26, v121, v5, v26
  v_dot2_f32_bf16 v26, v122, v6, v26
  v_dot2_f32_bf16 v26, v123, v7, v26
  v_add_f32_dpp v28, v24, v24 row_ror:8 row_mask:0xf bank_mask:0x3
  v_add_f32_dpp v28, v25, v25 row_ror:8 row_mask:0xf bank_mask:0xc
  s_cbranch_vccz L_w80h
  s_bitcmp0_b32 vcc_lo, 1
  s_cbranch_scc1 L_w80m
  s_waitcnt vmcnt(3)
L_w80m:
  s_waitcnt vmcnt(4)
L_w80h:
  s_waitcnt vmcnt(5)
  buffer_load_dwordx4 v[148:151], v60, s[48:51], s52 offen offset:2560 nt
  v_dot2_f32_bf16 v27, v124, v4, 0
  v_dot2_f32_bf16 v27, v125, v5, v27
  v_dot2_f32_bf16 v27, v126, v6, v27
  v_dot2_f32_bf16 v27, v127, v7, v27
  v_add_f32_dpp v29, v26, v26 row_ror:8 row_mask:0xf bank_mask:0x3
  s_nop 1
  v_add_f32_dpp v29, v27, v27 row_ror:8 row_mask:0xf bank_mask:0xc
  v_add_f32_dpp v31, v28, v28 row_shl:4 row_mask:0xf bank_mask:0x5
  s_nop 0
  v_add_f32_dpp v31, v29, v29 row_shr:4 row_mask:0xf bank_mask:0xa
  v_add_f32_dpp v52, v30, v30 quad_perm:[2,3,0,1] row_mask:0xf bank_mask:0xf
  s_nop 0
  v_add_f32_dpp v53, v31, v31 quad_perm:[2,3,0,1] row_mask:0xf bank_mask:0xf
  v_cndmask_b32 v33, v52, v53, s[54:55]
  v_add_f32_dpp v52, v32, v32 quad_perm:[1,0,3,2] row_mask:0xf bank_mask:0xf
  s_nop 0
  v_add_f32_dpp v53, v33, v33 quad_perm:[1,0,3,2] row_mask:0xf bank_mask:0xf
  v_cndmask_b32 v52, v52, v53, s[56:57]
  v_cvt_pk_bf16_f32 v52, v52, v52
  v_lshlrev_b32 v52, 16, v52
  v_mul_f32 v52, 0x3db504f3, v52
  v_cvt_pk_bf16_f32 v52, v52, v52
  v_lshlrev_b32 v49, 16, v52
  v_max3_f32 v50, v34, v35, v36
  v_max3_f32 v50, v50, v37, v38
  v_max3_f32 v50, v50, v39, v40
  v_max3_f32 v50, v50, v41, v42
  v_max3_f32 v50, v50, v43, v44
  v_max3_f32 v50, v50, v45, v46
  v_max3_f32 v50, v50, v47, v48
  v_max_f32 v50, v50, v49
  s_nop 1
  v_max_f32_dpp v50, v50, v50 quad_perm:[1,0,3,2] row_mask:0xf bank_mask:0xf
  s_nop 1
  v_max_f32_dpp v50, v50, v50 quad_perm:[2,3,0,1] row_mask:0xf bank_mask:0xf
  s_nop 1
  v_max_f32_dpp v50, v50, v50 row_half_mirror row_mask:0xf bank_mask:0xf
  s_nop 1
  v_max_f32_dpp v50, v50, v50 row_mirror row_mask:0xf bank_mask:0xf
  s_nop 1
  v_max_f32_dpp v50, v50, v50 row_bcast:15 row_mask:0xa bank_mask:0xf
  s_nop 1
  v_max_f32_dpp v50, v50, v50 row_bcast:31 row_mask:0xc bank_mask:0xf
  s_nop 0
  v_readlane_b32 s60, v50, 63
  s_cbranch_vccz L_w81h
  s_bitcmp0_b32 vcc_lo, 1
  s_cbranch_scc1 L_w81m
  s_waitcnt vmcnt(3)
L_w81m:
  s_waitcnt vmcnt(4)
L_w81h:
  s_waitcnt vmcnt(5)
  buffer_load_dwordx4 v[152:155], v60, s[48:51], s52 offen offset:3072 nt
  v_subrev_f32 v34, s60, v34
  v_subrev_f32 v35, s60, v35
  v_subrev_f32 v36, s60, v36
  v_subrev_f32 v37, s60, v37
  v_mul_f32 v34, 0x3fb8aa3b, v34
  v_mul_f32 v35, 0x3fb8aa3b, v35
  v_mul_f32 v36, 0x3fb8aa3b, v36
  v_mul_f32 v37, 0x3fb8aa3b, v37
  v_exp_f32 v34, v34
  v_exp_f32 v35, v35
  v_exp_f32 v36, v36
  v_exp_f32 v37, v37
  v_mov_b32 v54, v34
  v_add_f32 v54, v54, v35
  v_add_f32 v54, v54, v36
  v_add_f32 v54, v54, v37
  v_subrev_f32 v38, s60, v38
  v_subrev_f32 v39, s60, v39
  v_subrev_f32 v40, s60, v40
  v_subrev_f32 v41, s60, v41
  v_mul_f32 v38, 0x3fb8aa3b, v38
  v_mul_f32 v39, 0x3fb8aa3b, v39
  v_mul_f32 v40, 0x3fb8aa3b, v40
  v_mul_f32 v41, 0x3fb8aa3b, v41
  v_exp_f32 v38, v38
  v_exp_f32 v39, v39
  v_exp_f32 v40, v40
  v_exp_f32 v41, v41
  v_add_f32 v54, v54, v38
  v_add_f32 v54, v54, v39
  v_add_f32 v54, v54, v40
  v_add_f32 v54, v54, v41
  s_cbranch_vccz L_w82h
  s_bitcmp0_b32 vcc_lo, 1
  s_cbranch_scc1 L_w82m
  s_waitcnt vmcnt(3)
L_w82m:
  s_waitcnt vmcnt(4)
L_w82h:
  s_waitcnt vmcnt(5)
  buffer_load_dwordx4 v[156:159], v60, s[48:51], s52 offen offset:3584 nt
  v_subrev_f32 v42, s60, v42
  v_subrev_f32 v43, s60, v43
  v_subrev_f32 v44, s60, v44
  v_subrev_f32 v45, s60, v45
  v_mul_f32 v42, 0x3fb8aa3b, v42
  v_mul_f32 v43, 0x3fb8aa3b, v43
  v_mul_f32 v44, 0x3fb8aa3b, v44
  v_mul_f32 v45, 0x3fb8aa3b, v45
  v_exp_f32 v42, v42
  v_exp_f32 v43, v43
  v_exp_f32 v44, v44
  v_exp_f32 v45, v45
  v_add_f32 v54, v54, v42
  v_add_f32 v54, v54, v43
  v_add_f32 v54, v54, v44
  v_add_f32 v54, v54, v45
  v_subrev_f32 v46, s60, v46
  v_subrev_f32 v47, s60, v47
  v_subrev_f32 v48, s60, v48
  v_subrev_f32 v49, s60, v49
  v_mul_f32 v46, 0x3fb8aa3b, v46
  v_mul_f32 v47, 0x3fb8aa3b, v47
  v_mul_f32 v48, 0x3fb8aa3b, v48
  v_mul_f32 v49, 0x3fb8aa3b, v49
  v_exp_f32 v46, v46
  v_exp_f32 v47, v47
  v_exp_f32 v48, v48
  v_exp_f32 v49, v49
  v_add_f32 v54, v54, v46
  v_add_f32 v54, v54, v47
  v_add_f32 v54, v54, v48
  v_add_f32 v54, v54, v49
  s_cbranch_vccz L_w83h
  s_bitcmp0_b32 vcc_lo, 1
  s_cbranch_scc1 L_w83m
  s_waitcnt vmcnt(3)
L_w83m:
  s_waitcnt vmcnt(4)
L_w83h:
  s_waitcnt vmcnt(5)
  s_add_u32 s52, s52, 0x4000
  buffer_load_dwordx4 v[160:163], v60, s[48:51], s52 offen offset:0 nt
  s_waitcnt lgkmcnt(0)
  v_readfirstlane_b32 s66, v58
  v_readfirstlane_b32 s70, v59
  s_and_b32 s66, s66, s72
  s_cmp_eq_u32 s71, 0
  s_cbranch_scc1 L_w84
  s_cmp_lt_u32 s68, 7
  s_cselect_b32 s70, 5, 4
  s_cmp_lt_u32 s68, 1
  s_cselect_b32 s70, 7, s70
  v_mov_b32 v59, s70
  ds_write_b32 v57, v59 offset:5196
L_w84:
  s_cmp_eq_u32 s70, 0
  s_cselect_b32 s70, 1, s70
  s_and_b32 s84, s70, 3
  v_readfirstlane_b32 s69, v51
  s_lshr_b32 s70, s84, 1
  s_cmp_eq_u32 s69, 3
  s_cselect_b32 vcc_lo, s70, s84
  s_lshl_b32 s70, s84, 1
  s_or_b32 s70, s70, 1
  s_and_b32 s70, s70, 3
  s_cmp_eq_u32 s69, 0
  s_cselect_b32 vcc_lo, s70, vcc_lo
  v_add_f32_dpp v54, v54, v54 quad_perm:[1,0,3,2] row_mask:0xf bank_mask:0xf
  s_nop 1
  v_add_f32_dpp v54, v54, v54 quad_perm:[2,3,0,1] row_mask:0xf bank_mask:0xf
  s_nop 1
  v_add_f32_dpp v54, v54, v54 row_half_mirror row_mask:0xf bank_mask:0xf
  s_nop 1
  v_add_f32_dpp v54, v54, v54 row_mirror row_mask:0xf bank_mask:0xf
  s_nop 1
  v_add_f32_dpp v54, v54, v54 row_bcast:15 row_mask:0xa bank_mask:0xf
  s_nop 1
  v_add_f32_dpp v54, v54, v54 row_bcast:31 row_mask:0xc bank_mask:0xf
  s_nop 0
  v_readlane_b32 s61, v54, 63
  s_lshl_b32 s62, s3, 3
  v_mov_b32 v52, s60
  v_mov_b32 v53, s61
  v_mov_b32 v55, s62
  ds_write_b64 v55, v[52:53] offset:5120
  ds_add_u32 v57, v56 offset:5200
  v_mov_b32 v20, 0
  v_mov_b32 v21, 0
  v_mov_b32 v22, 0
  v_mov_b32 v23, 0
  s_cbranch_vccz L_w85h
  s_bitcmp0_b32 vcc_lo, 1
  s_cbranch_scc1 L_w85m
  s_waitcnt vmcnt(3)
L_w85m:
  s_waitcnt vmcnt(4)
L_w85h:
  s_waitcnt vmcnt(5)
  buffer_load_dwordx4 v[164:167], v60, s[48:51], s52 offen offset:512 nt
  s_cbranch_vccz L_w86h
  s_bitcmp0_b32 vcc_lo, 1
  s_cbranch_scc1 L_w86m
  s_waitcnt vmcnt(3)
L_w86m:
  s_waitcnt vmcnt(4)
L_w86h:
  s_waitcnt vmcnt(5)
  buffer_load_dwordx4 v[168:171], v60, s[48:51], s52 offen offset:1024 nt
  s_cbranch_vccz L_w87h
  s_bitcmp0_b32 vcc_lo, 1
  s_cbranch_scc1 L_w87m
  s_waitcnt vmcnt(3)
L_w87m:
  s_waitcnt vmcnt(4)
L_w87h:
  s_waitcnt vmcnt(5)
  buffer_load_dwordx4 v[172:175], v60, s[48:51], s52 offen offset:1536 nt
  s_cbranch_vccz L_w88h
  s_bitcmp0_b32 vcc_lo, 1
  s_cbranch_scc1 L_w88m
  s_waitcnt vmcnt(3)
L_w88m:
  s_waitcnt vmcnt(4)
L_w88h:
  s_waitcnt vmcnt(5)
  buffer_load_dwordx4 v[176:179], v60, s[48:51], s52 offen offset:2048 nt
  s_cbranch_vccz L_w89h
  s_bitcmp0_b32 vcc_lo, 1
  s_cbranch_scc1 L_w89m
  s_waitcnt vmcnt(3)
L_w89m:
  s_waitcnt vmcnt(4)
L_w89h:
  s_waitcnt vmcnt(5)
  buffer_load_dwordx4 v[180:183], v60, s[48:51], s52 offen offset:2560 nt
  s_cbranch_vccz L_w90h
  s_bitcmp0_b32 vcc_lo, 1
  s_cbranch_scc1 L_w90m
  s_waitcnt vmcnt(3)
L_w90m:
  s_waitcnt vmcnt(4)
L_w90h:
  s_waitcnt vmcnt(5)
  buffer_load_dwordx4 v[184:187], v60, s[48:51], s52 offen offset:3072 nt
L_sc:
  ds_read_b32 v54, v57 offset:5200
  ds_read_b128 v[24:27], v57 offset:5120
  ds_read_b128 v[28:31], v57 offset:5136
  s_waitcnt lgkmcnt(0)
  v_readfirstlane_b32 s61, v54
  s_nop 0
  s_cmp_lt_u32 s61, 256
  s_cbranch_scc1 L_sc
  v_max3_f32 v32, v24, v26, v28
  v_max_f32 v32, v32, v30
  v_sub_f32 v24, v24, v32
  v_sub_f32 v26, v26, v32
  v_sub_f32 v28, v28, v32
  v_sub_f32 v30, v30, v32
  v_sub_f32 v33, s60, v32
  v_mul_f32 v24, 0x3fb8aa3b, v24
  v_mul_f32 v26, 0x3fb8aa3b, v26
  v_mul_f32 v28, 0x3fb8aa3b, v28
  v_mul_f32 v30, 0x3fb8aa3b, v30
  v_mul_f32 v33, 0x3fb8aa3b, v33
  v_exp_f32 v24, v24
  v_exp_f32 v26, v26
  v_exp_f32 v28, v28
  v_exp_f32 v30, v30
  v_exp_f32 v33, v33
  v_mul_f32 v32, v24, v25
  v_fmac_f32 v32, v26, v27
  v_fmac_f32 v32, v28, v29
  v_fmac_f32 v32, v30, v31
  v_rcp_f32 v32, v32
  s_nop 0
  v_mul_f32 v32, v32, v33
  v_mul_f32 v34, v34, v32
  v_mul_f32 v35, v35, v32
  v_mul_f32 v36, v36, v32
  v_mul_f32 v37, v37, v32
  v_mul_f32 v38, v38, v32
  v_mul_f32 v39, v39, v32
  v_mul_f32 v40, v40, v32
  v_mul_f32 v41, v41, v32
  v_mul_f32 v42, v42, v32
  v_mul_f32 v43, v43, v32
  v_mul_f32 v44, v44, v32
  v_mul_f32 v45, v45, v32
  v_mul_f32 v46, v46, v32
  v_mul_f32 v47, v47, v32
  v_mul_f32 v48, v48, v32
  v_mul_f32 v49, v49, v32
  v_cvt_pk_bf16_f32 v34, v34, v34
  v_cvt_pk_bf16_f32 v35, v35, v35
  v_cvt_pk_bf16_f32 v36, v36, v36
  v_cvt_pk_bf16_f32 v37, v37, v37
  v_cvt_pk_bf16_f32 v38, v38, v38
  v_cvt_pk_bf16_f32 v39, v39, v39
  v_cvt_pk_bf16_f32 v40, v40, v40
  v_cvt_pk_bf16_f32 v41, v41, v41
  v_cvt_pk_bf16_f32 v42, v42, v42
  v_cvt_pk_bf16_f32 v43, v43, v43
  v_cvt_pk_bf16_f32 v44, v44, v44
  v_cvt_pk_bf16_f32 v45, v45, v45
  v_cvt_pk_bf16_f32 v46, v46, v46
  v_cvt_pk_bf16_f32 v47, v47, v47
  v_cvt_pk_bf16_f32 v48, v48, v48
  v_cvt_pk_bf16_f32 v49, v49, v49
  s_mov_b32 s53, 0
L_vloop:
  v_mov_b32 v55, v34
  s_nop 1
  v_and_b32_dpp v12, v55, v8 row_newbcast:0 row_mask:0xf bank_mask:0xf
  v_and_b32_dpp v13, v55, v9 row_newbcast:0 row_mask:0xf bank_mask:0xf
  v_and_b32_dpp v14, v55, v10 row_newbcast:0 row_mask:0xf bank_mask:0xf
  v_and_b32_dpp v15, v55, v11 row_newbcast:0 row_mask:0xf bank_mask:0xf
  s_cbranch_vccz L_w91h
  s_bitcmp0_b32 vcc_lo, 1
  s_cbranch_scc1 L_w91m
  s_waitcnt vmcnt(3)
L_w91m:
  s_waitcnt vmcnt(4)
L_w91h:
  s_waitcnt vmcnt(5)
  buffer_load_dwordx4 v[188:191], v60, s[48:51], s52 offen offset:3584 nt
  s_mov_b32 vcc_lo, s84
  v_mfma_f32_16x16x32_bf16 v[20:23], v[12:15], v[128:131], v[20:23]
  v_mov_b32 v34, v35
  v_and_b32_dpp v16, v55, v8 row_newbcast:8 row_mask:0xf bank_mask:0xf
  v_and_b32_dpp v17, v55, v9 row_newbcast:8 row_mask:0xf bank_mask:0xf
  v_and_b32_dpp v18, v55, v10 row_newbcast:8 row_mask:0xf bank_mask:0xf
  v_and_b32_dpp v19, v55, v11 row_newbcast:8 row_mask:0xf bank_mask:0xf
  s_cbranch_vccz L_w92h
  s_bitcmp0_b32 vcc_lo, 1
  s_cbranch_scc1 L_w92m
  s_waitcnt vmcnt(3)
L_w92m:
  s_waitcnt vmcnt(4)
L_w92h:
  s_waitcnt vmcnt(5)
  s_add_u32 s52, s52, 0xc000
  buffer_load_dwordx4 v[128:131], v60, s[48:51], s52 offen offset:0 nt
  s_add_u32 s63, s63, 1
  ds_read_b64 v[58:59], v57 offset:5192
  v_mov_b32 v0, s63
  v_lshlrev_b32 v0, 2, v0
  s_mov_b64 exec, 1
  ds_add_rtn_u32 v51, v0, v56 offset:5376
  s_mov_b64 exec, -1
  s_and_b32 s71, s63, 1
  s_cselect_b32 s71, 0, s66
  s_cmp_eq_u32 s71, 0
  s_cbranch_scc1 L_w93
  s_lshr_b32 s67, s63, 1
  s_and_b32 s69, s67, 3
  s_lshl_b32 s69, s69, 2
  s_lshr_b32 s69, 0x5030, s69
  s_and_b32 s69, s69, 15
  s_bfm_b32 s70, s69, 0
  s_and_b32 s70, s70, s2
  s_add_u32 s68, s69, 3
  s_lshr_b32 s68, s2, s68
  s_lshl_b32 s68, s68, s69
  s_or_b32 s68, s68, s70
  s_mul_i32 s68, s68, 4352
  s_lshl_b32 s69, s63, 2
  s_add_u32 s69, s69, s68
  s_mov_b32 s68, 1
  s_atomic_add s68, s[64:65], s69 glc
L_w93:
  v_mfma_f32_16x16x32_bf16 v[20:23], v[16:19], v[132:135], v[20:23]
  v_mov_b32 v35, v36
  v_and_b32_dpp v12, v55, v8 row_newbcast:4 row_mask:0xf bank_mask:0xf
  v_and_b32_dpp v13, v55, v9 row_newbcast:4 row_mask:0xf bank_mask:0xf
  v_and_b32_dpp v14, v55, v10 row_newbcast:4 row_mask:0xf bank_mask:0xf
  v_and_b32_dpp v15, v55, v11 row_newbcast:4 row_mask:0xf bank_mask:0xf
  s_cbranch_vccz L_w94h
  s_bitcmp0_b32 vcc_lo, 1
  s_cbranch_scc1 L_w94m
  s_waitcnt vmcnt(3)
L_w94m:
  s_waitcnt vmcnt(4)
L_w94h:
  s_waitcnt vmcnt(5)
  buffer_load_dwordx4 v[132:135], v60, s[48:51], s52 offen offset:512 nt
  v_mfma_f32_16x16x32_bf16 v[20:23], v[12:15], v[136:139], v[20:23]
  v_mov_b32 v36, v37
  v_and_b32_dpp v16, v55, v8 row_newbcast:12 row_mask:0xf bank_mask:0xf
  v_and_b32_dpp v17, v55, v9 row_newbcast:12 row_mask:0xf bank_mask:0xf
  v_and_b32_dpp v18, v55, v10 row_newbcast:12 row_mask:0xf bank_mask:0xf
  v_and_b32_dpp v19, v55, v11 row_newbcast:12 row_mask:0xf bank_mask:0xf
  s_cbranch_vccz L_w95h
  s_bitcmp0_b32 vcc_lo, 1
  s_cbranch_scc1 L_w95m
  s_waitcnt vmcnt(3)
L_w95m:
  s_waitcnt vmcnt(4)
L_w95h:
  s_waitcnt vmcnt(5)
  buffer_load_dwordx4 v[136:139], v60, s[48:51], s52 offen offset:1024 nt
  v_mfma_f32_16x16x32_bf16 v[20:23], v[16:19], v[140:143], v[20:23]
  v_mov_b32 v37, v38
  v_and_b32_dpp v12, v55, v8 row_newbcast:2 row_mask:0xf bank_mask:0xf
  v_and_b32_dpp v13, v55, v9 row_newbcast:2 row_mask:0xf bank_mask:0xf
  v_and_b32_dpp v14, v55, v10 row_newbcast:2 row_mask:0xf bank_mask:0xf
  v_and_b32_dpp v15, v55, v11 row_newbcast:2 row_mask:0xf bank_mask:0xf
  s_cbranch_vccz L_w96h
  s_bitcmp0_b32 vcc_lo, 1
  s_cbranch_scc1 L_w96m
  s_waitcnt vmcnt(3)
L_w96m:
  s_waitcnt vmcnt(4)
L_w96h:
  s_waitcnt vmcnt(5)
  buffer_load_dwordx4 v[140:143], v60, s[48:51], s52 offen offset:1536 nt
  v_mfma_f32_16x16x32_bf16 v[20:23], v[12:15], v[144:147], v[20:23]
  v_mov_b32 v38, v39
  v_and_b32_dpp v16, v55, v8 row_newbcast:10 row_mask:0xf bank_mask:0xf
  v_and_b32_dpp v17, v55, v9 row_newbcast:10 row_mask:0xf bank_mask:0xf
  v_and_b32_dpp v18, v55, v10 row_newbcast:10 row_mask:0xf bank_mask:0xf
  v_and_b32_dpp v19, v55, v11 row_newbcast:10 row_mask:0xf bank_mask:0xf
  s_cbranch_vccz L_w97h
  s_bitcmp0_b32 vcc_lo, 1
  s_cbranch_scc1 L_w97m
  s_waitcnt vmcnt(3)
L_w97m:
  s_waitcnt vmcnt(4)
L_w97h:
  s_waitcnt vmcnt(5)
  buffer_load_dwordx4 v[144:147], v60, s[48:51], s52 offen offset:2048 nt
  v_mfma_f32_16x16x32_bf16 v[20:23], v[16:19], v[148:151], v[20:23]
  v_mov_b32 v39, v40
  v_and_b32_dpp v12, v55, v8 row_newbcast:6 row_mask:0xf bank_mask:0xf
  v_and_b32_dpp v13, v55, v9 row_newbcast:6 row_mask:0xf bank_mask:0xf
  v_and_b32_dpp v14, v55, v10 row_newbcast:6 row_mask:0xf bank_mask:0xf
  v_and_b32_dpp v15, v55, v11 row_newbcast:6 row_mask:0xf bank_mask:0xf
  s_cbranch_vccz L_w98h
  s_bitcmp0_b32 vcc_lo, 1
  s_cbranch_scc1 L_w98m
  s_waitcnt vmcnt(3)
L_w98m:
  s_waitcnt vmcnt(4)
L_w98h:
  s_waitcnt vmcnt(5)
  buffer_load_dwordx4 v[148:151], v60, s[48:51], s52 offen offset:2560 nt
  v_mfma_f32_16x16x32_bf16 v[20:23], v[12:15], v[152:155], v[20:23]
  v_mov_b32 v40, v41
  v_and_b32_dpp v16, v55, v8 row_newbcast:14 row_mask:0xf bank_mask:0xf
  v_and_b32_dpp v17, v55, v9 row_newbcast:14 row_mask:0xf bank_mask:0xf
  v_and_b32_dpp v18, v55, v10 row_newbcast:14 row_mask:0xf bank_mask:0xf
  v_and_b32_dpp v19, v55, v11 row_newbcast:14 row_mask:0xf bank_mask:0xf
  s_cbranch_vccz L_w99h
  s_bitcmp0_b32 vcc_lo, 1
  s_cbranch_scc1 L_w99m
  s_waitcnt vmcnt(3)
L_w99m:
  s_waitcnt vmcnt(4)
L_w99h:
  s_waitcnt vmcnt(5)
  buffer_load_dwordx4 v[152:155], v60, s[48:51], s52 offen offset:3072 nt
  v_mfma_f32_16x16x32_bf16 v[20:23], v[16:19], v[156:159], v[20:23]
  v_mov_b32 v41, v42
  v_and_b32_dpp v12, v55, v8 row_newbcast:1 row_mask:0xf bank_mask:0xf
  v_and_b32_dpp v13, v55, v9 row_newbcast:1 row_mask:0xf bank_mask:0xf
  v_and_b32_dpp v14, v55, v10 row_newbcast:1 row_mask:0xf bank_mask:0xf
  v_and_b32_dpp v15, v55, v11 row_newbcast:1 row_mask:0xf bank_mask:0xf
  s_cbranch_vccz L_w100h
  s_bitcmp0_b32 vcc_lo, 1
  s_cbranch_scc1 L_w100m
  s_waitcnt vmcnt(3)
L_w100m:
  s_waitcnt vmcnt(4)
L_w100h:
  s_waitcnt vmcnt(5)
  buffer_load_dwordx4 v[156:159], v60, s[48:51], s52 offen offset:3584 nt
  v_mfma_f32_16x16x32_bf16 v[20:23], v[12:15], v[160:163], v[20:23]
  v_mov_b32 v42, v43
  v_and_b32_dpp v16, v55, v8 row_newbcast:9 row_mask:0xf bank_mask:0xf
  v_and_b32_dpp v17, v55, v9 row_newbcast:9 row_mask:0xf bank_mask:0xf
  v_and_b32_dpp v18, v55, v10 row_newbcast:9 row_mask:0xf bank_mask:0xf
  v_and_b32_dpp v19, v55, v11 row_newbcast:9 row_mask:0xf bank_mask:0xf
  s_cbranch_vccz L_w101h
  s_bitcmp0_b32 vcc_lo, 1
  s_cbranch_scc1 L_w101m
  s_waitcnt vmcnt(3)
L_w101m:
  s_waitcnt vmcnt(4)
L_w101h:
  s_waitcnt vmcnt(5)
  s_add_u32 s52, s52, 0x4000
  buffer_load_dwordx4 v[160:163], v60, s[48:51], s52 offen offset:0 nt
  s_waitcnt lgkmcnt(0)
  v_readfirstlane_b32 s66, v58
  v_readfirstlane_b32 s70, v59
  s_and_b32 s66, s66, s72
  s_cmp_eq_u32 s71, 0
  s_cbranch_scc1 L_w102
  s_cmp_lt_u32 s68, 7
  s_cselect_b32 s70, 5, 4
  s_cmp_lt_u32 s68, 1
  s_cselect_b32 s70, 7, s70
  v_mov_b32 v59, s70
  ds_write_b32 v57, v59 offset:5196
L_w102:
  s_cmp_eq_u32 s70, 0
  s_cselect_b32 s70, 1, s70
  s_and_b32 s84, s70, 3
  v_readfirstlane_b32 s69, v51
  s_lshr_b32 s70, s84, 1
  s_cmp_eq_u32 s69, 3
  s_cselect_b32 vcc_lo, s70, s84
  s_lshl_b32 s70, s84, 1
  s_or_b32 s70, s70, 1
  s_and_b32 s70, s70, 3
  s_cmp_eq_u32 s69, 0
  s_cselect_b32 vcc_lo, s70, vcc_lo
  v_mfma_f32_16x16x32_bf16 v[20:23], v[16:19], v[164:167], v[20:23]
  v_mov_b32 v43, v44
  v_and_b32_dpp v12, v55, v8 row_newbcast:5 row_mask:0xf bank_mask:0xf
  v_and_b32_dpp v13, v55, v9 row_newbcast:5 row_mask:0xf bank_mask:0xf
  v_and_b32_dpp v14, v55, v10 row_newbcast:5 row_mask:0xf bank_mask:0xf
  v_and_b32_dpp v15, v55, v11 row_newbcast:5 row_mask:0xf bank_mask:0xf
  s_cbranch_vccz L_w103h
  s_bitcmp0_b32 vcc_lo, 1
  s_cbranch_scc1 L_w103m
  s_waitcnt vmcnt(3)
L_w103m:
  s_waitcnt vmcnt(4)
L_w103h:
  s_waitcnt vmcnt(5)
  buffer_load_dwordx4 v[164:167], v60, s[48:51], s52 offen offset:512 nt
  v_mfma_f32_16x16x32_bf16 v[20:23], v[12:15], v[168:171], v[20:23]
  v_mov_b32 v44, v45
  v_and_b32_dpp v16, v55, v8 row_newbcast:13 row_mask:0xf bank_mask:0xf
  v_and_b32_dpp v17, v55, v9 row_newbcast:13 row_mask:0xf bank_mask:0xf
  v_and_b32_dpp v18, v55, v10 row_newbcast:13 row_mask:0xf bank_mask:0xf
  v_and_b32_dpp v19, v55, v11 row_newbcast:13 row_mask:0xf bank_mask:0xf
  s_cbranch_vccz L_w104h
  s_bitcmp0_b32 vcc_lo, 1
  s_cbranch_scc1 L_w104m
  s_waitcnt vmcnt(3)
L_w104m:
  s_waitcnt vmcnt(4)
L_w104h:
  s_waitcnt vmcnt(5)
  buffer_load_dwordx4 v[168:171], v60, s[48:51], s52 offen offset:1024 nt
  v_mfma_f32_16x16x32_bf16 v[20:23], v[16:19], v[172:175], v[20:23]
  v_mov_b32 v45, v46
  v_and_b32_dpp v12, v55, v8 row_newbcast:3 row_mask:0xf bank_mask:0xf
  v_and_b32_dpp v13, v55, v9 row_newbcast:3 row_mask:0xf bank_mask:0xf
  v_and_b32_dpp v14, v55, v10 row_newbcast:3 row_mask:0xf bank_mask:0xf
  v_and_b32_dpp v15, v55, v11 row_newbcast:3 row_mask:0xf bank_mask:0xf
  s_cbranch_vccz L_w105h
  s_bitcmp0_b32 vcc_lo, 1
  s_cbranch_scc1 L_w105m
  s_waitcnt vmcnt(3)
L_w105m:
  s_waitcnt vmcnt(4)
L_w105h:
  s_waitcnt vmcnt(5)
  buffer_load_dwordx4 v[172:175], v60, s[48:51], s52 offen offset:1536 nt
  v_mfma_f32_16x16x32_bf16 v[20:23], v[12:15], v[176:179], v[20:23]
  v_mov_b32 v46, v47
  v_and_b32_dpp v16, v55, v8 row_newbcast:11 row_mask:0xf bank_mask:0xf
  v_and_b32_dpp v17, v55, v9 row_newbcast:11 row_mask:0xf bank_mask:0xf
  v_and_b32_dpp v18, v55, v10 row_newbcast:11 row_mask:0xf bank_mask:0xf
  v_and_b32_dpp v19, v55, v11 row_newbcast:11 row_mask:0xf bank_mask:0xf
  s_cbranch_vccz L_w106h
  s_bitcmp0_b32 vcc_lo, 1
  s_cbranch_scc1 L_w106m
  s_waitcnt vmcnt(3)
L_w106m:
  s_waitcnt vmcnt(4)
L_w106h:
  s_waitcnt vmcnt(5)
  buffer_load_dwordx4 v[176:179], v60, s[48:51], s52 offen offset:2048 nt
  v_mfma_f32_16x16x32_bf16 v[20:23], v[16:19], v[180:183], v[20:23]
  v_mov_b32 v47, v48
  v_and_b32_dpp v12, v55, v8 row_newbcast:7 row_mask:0xf bank_mask:0xf
  v_and_b32_dpp v13, v55, v9 row_newbcast:7 row_mask:0xf bank_mask:0xf
  v_and_b32_dpp v14, v55, v10 row_newbcast:7 row_mask:0xf bank_mask:0xf
  v_and_b32_dpp v15, v55, v11 row_newbcast:7 row_mask:0xf bank_mask:0xf
  s_cbranch_vccz L_w107h
  s_bitcmp0_b32 vcc_lo, 1
  s_cbranch_scc1 L_w107m
  s_waitcnt vmcnt(3)
L_w107m:
  s_waitcnt vmcnt(4)
L_w107h:
  s_waitcnt vmcnt(5)
  buffer_load_dwordx4 v[180:183], v60, s[48:51], s52 offen offset:2560 nt
  v_mfma_f32_16x16x32_bf16 v[20:23], v[12:15], v[184:187], v[20:23]
  v_mov_b32 v48, v49
  v_and_b32_dpp v16, v55, v8 row_newbcast:15 row_mask:0xf bank_mask:0xf
  v_and_b32_dpp v17, v55, v9 row_newbcast:15 row_mask:0xf bank_mask:0xf
  v_and_b32_dpp v18, v55, v10 row_newbcast:15 row_mask:0xf bank_mask:0xf
  v_and_b32_dpp v19, v55, v11 row_newbcast:15 row_mask:0xf bank_mask:0xf
  s_cbranch_vccz L_w108h
  s_bitcmp0_b32 vcc_lo, 1
  s_cbranch_scc1 L_w108m
  s_waitcnt vmcnt(3)
L_w108m:
  s_waitcnt vmcnt(4)
L_w108h:
  s_waitcnt vmcnt(5)
  buffer_load_dwordx4 v[184:187], v60, s[48:51], s52 offen offset:3072 nt
  v_mfma_f32_16x16x32_bf16 v[20:23], v[16:19], v[188:191], v[20:23]
  s_add_u32 s53, s53, 1
  s_cmp_lg_u32 s53, 8
  s_cbranch_scc1 L_w109
  ds_write_b32 v57, v56 offset:5188
L_w109:
  s_cmp_lt_u32 s53, 15
  s_cbranch_scc1 L_vloop
  v_lshlrev_b32 v52, 5, v3
  v_lshl_add_u32 v52, v2, 4, v52
  s_lshl_b32 s62, s3, 9
  v_add_u32 v52, s62, v52
  v_mov_b32 v55, v34
  s_nop 1
  v_and_b32_dpp v12, v55, v8 row_newbcast:0 row_mask:0xf bank_mask:0xf
  v_and_b32_dpp v13, v55, v9 row_newbcast:0 row_mask:0xf bank_mask:0xf
  v_and_b32_dpp v14, v55, v10 row_newbcast:0 row_mask:0xf bank_mask:0xf
  v_and_b32_dpp v15, v55, v11 row_newbcast:0 row_mask:0xf bank_mask:0xf
  s_cbranch_vccz L_w110h
  s_bitcmp0_b32 vcc_lo, 1
  s_cbranch_scc1 L_w110m
  s_waitcnt vmcnt(3)
L_w110m:
  s_waitcnt vmcnt(4)
L_w110h:
  s_waitcnt vmcnt(5)
  buffer_load_dwordx4 v[188:191], v60, s[48:51], s52 offen offset:3584 nt
  s_mov_b32 vcc_lo, s84
  v_mfma_f32_16x16x32_bf16 v[20:23], v[12:15], v[128:131], v[20:23]
  v_and_b32_dpp v16, v55, v8 row_newbcast:8 row_mask:0xf bank_mask:0xf
  v_and_b32_dpp v17, v55, v9 row_newbcast:8 row_mask:0xf bank_mask:0xf
  v_and_b32_dpp v18, v55, v10 row_newbcast:8 row_mask:0xf bank_mask:0xf
  v_and_b32_dpp v19, v55, v11 row_newbcast:8 row_mask:0xf bank_mask:0xf
  s_nop 1
  v_mfma_f32_16x16x32_bf16 v[20:23], v[16:19], v[132:135], v[20:23]
  v_and_b32_dpp v12, v55, v8 row_newbcast:4 row_mask:0xf bank_mask:0xf
  v_and_b32_dpp v13, v55, v9 row_newbcast:4 row_mask:0xf bank_mask:0xf
  v_and_b32_dpp v14, v55, v10 row_newbcast:4 row_mask:0xf bank_mask:0xf
  v_and_b32_dpp v15, v55, v11 row_newbcast:4 row_mask:0xf bank_mask:0xf
  s_nop 1
  v_mfma_f32_16x16x32_bf16 v[20:23], v[12:15], v[136:139], v[20:23]
  v_and_b32_dpp v16, v55, v8 row_newbcast:12 row_mask:0xf bank_mask:0xf
  v_and_b32_dpp v17, v55, v9 row_newbcast:12 row_mask:0xf bank_mask:0xf
  v_and_b32_dpp v18, v55, v10 row_newbcast:12 row_mask:0xf bank_mask:0xf
  v_and_b32_dpp v19, v55, v11 row_newbcast:12 row_mask:0xf bank_mask:0xf
  s_nop 1
  v_mfma_f32_16x16x32_bf16 v[20:23], v[16:19], v[140:143], v[20:23]
  v_and_b32_dpp v12, v55, v8 row_newbcast:2 row_mask:0xf bank_mask:0xf
  v_and_b32_dpp v13, v55, v9 row_newbcast:2 row_mask:0xf bank_mask:0xf
  v_and_b32_dpp v14, v55, v10 row_newbcast:2 row_mask:0xf bank_mask:0xf
  v_and_b32_dpp v15, v55, v11 row_newbcast:2 row_mask:0xf bank_mask:0xf
  s_nop 1
  v_mfma_f32_16x16x32_bf16 v[20:23], v[12:15], v[144:147], v[20:23]
  v_and_b32_dpp v16, v55, v8 row_newbcast:10 row_mask:0xf bank_mask:0xf
  v_and_b32_dpp v17, v55, v9 row_newbcast:10 row_mask:0xf bank_mask:0xf
  v_and_b32_dpp v18, v55, v10 row_newbcast:10 row_mask:0xf bank_mask:0xf
  v_and_b32_dpp v19, v55, v11 row_newbcast:10 row_mask:0xf bank_mask:0xf
  s_nop 1
  v_mfma_f32_16x16x32_bf16 v[20:23], v[16:19], v[148:151], v[20:23]
  v_and_b32_dpp v12, v55, v8 row_newbcast:6 row_mask:0xf bank_mask:0xf
  v_and_b32_dpp v13, v55, v9 row_newbcast:6 row_mask:0xf bank_mask:0xf
  v_and_b32_dpp v14, v55, v10 row_newbcast:6 row_mask:0xf bank_mask:0xf
  v_and_b32_dpp v15, v55, v11 row_newbcast:6 row_mask:0xf bank_mask:0xf
  s_nop 1
  v_mfma_f32_16x16x32_bf16 v[20:23], v[12:15], v[152:155], v[20:23]
  v_and_b32_dpp v16, v55, v8 row_newbcast:14 row_mask:0xf bank_mask:0xf
  v_and_b32_dpp v17, v55, v9 row_newbcast:14 row_mask:0xf bank_mask:0xf
  v_and_b32_dpp v18, v55, v10 row_newbcast:14 row_mask:0xf bank_mask:0xf
  v_and_b32_dpp v19, v55, v11 row_newbcast:14 row_mask:0xf bank_mask:0xf
  s_nop 1
  v_mfma_f32_16x16x32_bf16 v[20:23], v[16:19], v[156:159], v[20:23]
  v_and_b32_dpp v12, v55, v8 row_newbcast:1 row_mask:0xf bank_mask:0xf
  v_and_b32_dpp v13, v55, v9 row_newbcast:1 row_mask:0xf bank_mask:0xf
  v_and_b32_dpp v14, v55, v10 row_newbcast:1 row_mask:0xf bank_mask:0xf
  v_and_b32_dpp v15, v55, v11 row_newbcast:1 row_mask:0xf bank_mask:0xf
  s_nop 1
  v_mfma_f32_16x16x32_bf16 v[20:23], v[12:15], v[160:163], v[20:23]
  v_and_b32_dpp v16, v55, v8 row_newbcast:9 row_mask:0xf bank_mask:0xf
  v_and_b32_dpp v17, v55, v9 row_newbcast:9 row_mask:0xf bank_mask:0xf
  v_and_b32_dpp v18, v55, v10 row_newbcast:9 row_mask:0xf bank_mask:0xf
  v_and_b32_dpp v19, v55, v11 row_newbcast:9 row_mask:0xf bank_mask:0xf
  s_nop 1
  v_mfma_f32_16x16x32_bf16 v[20:23], v[16:19], v[164:167], v[20:23]
  v_and_b32_dpp v12, v55, v8 row_newbcast:5 row_mask:0xf bank_mask:0xf
  v_and_b32_dpp v13, v55, v9 row_newbcast:5 row_mask:0xf bank_mask:0xf
  v_and_b32_dpp v14, v55, v10 row_newbcast:5 row_mask:0xf bank_mask:0xf
  v_and_b32_dpp v15, v55, v11 row_newbcast:5 row_mask:0xf bank_mask:0xf
  s_waitcnt vmcnt(5)
  s_nop 0
  v_mfma_f32_16x16x32_bf16 v[20:23], v[12:15], v[168:171], v[20:23]
  v_and_b32_dpp v16, v55, v8 row_newbcast:13 row_mask:0xf bank_mask:0xf
  v_and_b32_dpp v17, v55, v9 row_newbcast:13 row_mask:0xf bank_mask:0xf
  v_and_b32_dpp v18, v55, v10 row_newbcast:13 row_mask:0xf bank_mask:0xf
  v_and_b32_dpp v19, v55, v11 row_newbcast:13 row_mask:0xf bank_mask:0xf
  s_waitcnt vmcnt(4)
  s_nop 0
  v_mfma_f32_16x16x32_bf16 v[20:23], v[16:19], v[172:175], v[20:23]
  v_and_b32_dpp v12, v55, v8 row_newbcast:3 row_mask:0xf bank_mask:0xf
  v_and_b32_dpp v13, v55, v9 row_newbcast:3 row_mask:0xf bank_mask:0xf
  v_and_b32_dpp v14, v55, v10 row_newbcast:3 row_mask:0xf bank_mask:0xf
  v_and_b32_dpp v15, v55, v11 row_newbcast:3 row_mask:0xf bank_mask:0xf
  s_waitcnt vmcnt(3)
  s_nop 0
  v_mfma_f32_16x16x32_bf16 v[20:23], v[12:15], v[176:179], v[20:23]
  v_and_b32_dpp v16, v55, v8 row_newbcast:11 row_mask:0xf bank_mask:0xf
  v_and_b32_dpp v17, v55, v9 row_newbcast:11 row_mask:0xf bank_mask:0xf
  v_and_b32_dpp v18, v55, v10 row_newbcast:11 row_mask:0xf bank_mask:0xf
  v_and_b32_dpp v19, v55, v11 row_newbcast:11 row_mask:0xf bank_mask:0xf
  s_waitcnt vmcnt(2)
  s_nop 0
  v_mfma_f32_16x16x32_bf16 v[20:23], v[16:19], v[180:183], v[20:23]
  v_and_b32_dpp v12, v55, v8 row_newbcast:7 row_mask:0xf bank_mask:0xf
  v_and_b32_dpp v13, v55, v9 row_newbcast:7 row_mask:0xf bank_mask:0xf
  v_and_b32_dpp v14, v55, v10 row_newbcast:7 row_mask:0xf bank_mask:0xf
  v_and_b32_dpp v15, v55, v11 row_newbcast:7 row_mask:0xf bank_mask:0xf
  s_waitcnt vmcnt(1)
  s_nop 0
  v_mfma_f32_16x16x32_bf16 v[20:23], v[12:15], v[184:187], v[20:23]
  v_and_b32_dpp v16, v55, v8 row_newbcast:15 row_mask:0xf bank_mask:0xf
  v_and_b32_dpp v17, v55, v9 row_newbcast:15 row_mask:0xf bank_mask:0xf
  v_and_b32_dpp v18, v55, v10 row_newbcast:15 row_mask:0xf bank_mask:0xf
  v_and_b32_dpp v19, v55, v11 row_newbcast:15 row_mask:0xf bank_mask:0xf
  s_waitcnt vmcnt(0)
  s_nop 0
  v_mfma_f32_16x16x32_bf16 v[20:23], v[16:19], v[188:191], v[20:23]
  s_mov_b32 exec_hi, 0
  s_nop 6
  ds_write_b128 v52, v[20:23] offset:3072
  s_mov_b64 exec, -1
  s_waitcnt lgkmcnt(0)
  s_barrier
  s_endpgm
L_helper2:
  s_load_dwordx8 s[24:31], s[0:1], 32
  s_load_dwordx8 s[32:39], s[0:1], 64
  s_load_dwordx2 s[40:41], s[0:1], 96
  v_and_b32 v26, 1, v3
  v_mov_b32 v27, 0xffff
  v_mov_b32 v28, 0xffff0000
  v_cmp_eq_u32 vcc, 1, v26
  v_lshrrev_b32 v29, 1, v3
  s_nop 0
  v_cndmask_b32 v26, v27, v28, vcc
  v_cmp_eq_u32 vcc, 0, v29
  s_nop 1
  v_cndmask_b32 v8, 0, v26, vcc
  v_cmp_eq_u32 vcc, 1, v29
  s_nop 1
  v_cndmask_b32 v9, 0, v26, vcc
  v_cmp_eq_u32 vcc, 2, v29
  s_nop 1
  v_cndmask_b32 v10, 0, v26, vcc
  v_cmp_eq_u32 vcc, 3, v29
  s_nop 1
  v_cndmask_b32 v11, 0, v26, vcc
  v_mov_b32 v60, 0
  v_mov_b32 v61, 0
  ds_write_b64 v60, v[60:61] offset:5184
  ds_write_b64 v60, v[60:61] offset:5192
  ds_write_b32 v60, v60 offset:5200
  v_lshlrev_b32 v28, 2, v1
  ds_write_b32 v28, v60 offset:5376
  v_lshl_add_u32 v33, v2, 4, s86
  v_lshlrev_b32 v35, 5, v3
  v_lshl_add_u32 v35, v2, 4, v35
  s_waitcnt lgkmcnt(0)
  s_mov_b32 s52, s28
  s_mov_b32 s53, s29
  s_mov_b32 s54, 1835008
  s_mov_b32 s55, 0x20000
  s_mov_b32 s56, s32
  s_mov_b32 s57, s33
  s_mov_b32 s58, 1835008
  s_mov_b32 s59, 0x20000
  s_mov_b32 s60, s24
  s_mov_b32 s61, s25
  s_mov_b32 s62, 4194304
  s_mov_b32 s63, 0x20000
  s_mov_b32 s64, s30
  s_mov_b32 s65, s31
  s_mov_b32 s66, 3584
  s_mov_b32 s67, 0x20000
  s_mov_b32 s68, s34
  s_mov_b32 s69, s35
  s_mov_b32 s70, 1024
  s_mov_b32 s71, 0x20000
  s_mov_b32 s72, s40
  s_mov_b32 s73, s41
  s_mov_b32 s74, 2097152
  s_mov_b32 s75, 0x20000
  s_mov_b32 s76, s36
  s_mov_b32 s77, s37
  s_mov_b32 s78, 8192
  s_mov_b32 s79, 0x20000
  s_mov_b32 s80, s38
  s_mov_b32 s81, s39
  s_mov_b32 s82, 256
  s_mov_b32 s83, 0x20000
  s_waitcnt vmcnt(4)
  v_lshlrev_b32 v40, 16, v36
  v_and_b32 v41, 0xffff0000, v36
  v_lshlrev_b32 v42, 16, v37
  v_and_b32 v43, 0xffff0000, v37
  v_lshlrev_b32 v44, 16, v38
  v_and_b32 v45, 0xffff0000, v38
  v_lshlrev_b32 v46, 16, v39
  v_and_b32 v47, 0xffff0000, v39
  v_add_f32 v26, v40, v41
  v_add_f32 v27, v42, v43
  v_add_f32 v28, v44, v45
  v_add_f32 v29, v46, v47
  v_add_f32 v26, v26, v27
  v_add_f32 v28, v28, v29
  v_add_f32 v26, v26, v28
  s_waitcnt vmcnt(3)
  s_mov_b32 s88, 131072
  buffer_load_dwordx4 v[208:211], v32, s[48:51], s88 offen nt
  v_add_f32_dpp v26, v26, v26 quad_perm:[1,0,3,2] row_mask:0xf bank_mask:0xf
  s_nop 1
  v_add_f32_dpp v26, v26, v26 quad_perm:[2,3,0,1] row_mask:0xf bank_mask:0xf
  s_nop 1
  v_add_f32_dpp v26, v26, v26 row_half_mirror row_mask:0xf bank_mask:0xf
  s_nop 1
  v_add_f32_dpp v26, v26, v26 row_mirror row_mask:0xf bank_mask:0xf
  s_nop 1
  v_add_f32_dpp v26, v26, v26 row_bcast:15 row_mask:0xa bank_mask:0xf
  s_nop 1
  v_add_f32_dpp v26, v26, v26 row_bcast:31 row_mask:0xc bank_mask:0xf
  s_nop 0
  v_readlane_b32 s89, v26, 63
  s_waitcnt vmcnt(3)
  s_mov_b32 s88, 139264
  buffer_load_dwordx4 v[212:215], v32, s[48:51], s88 offen nt
  v_mov_b32 v27, s89
  v_mul_f32 v27, 0x3b000000, v27
  v_sub_f32 v40, v40, v27
  v_sub_f32 v41, v41, v27
  v_sub_f32 v42, v42, v27
  v_sub_f32 v43, v43, v27
  v_sub_f32 v44, v44, v27
  v_sub_f32 v45, v45, v27
  v_sub_f32 v46, v46, v27
  v_sub_f32 v47, v47, v27
  v_mul_f32 v26, v40, v40
  v_fmac_f32 v26, v41, v41
  v_fmac_f32 v26, v42, v42
  v_fmac_f32 v26, v43, v43
  v_fmac_f32 v26, v44, v44
  v_fmac_f32 v26, v45, v45
  v_fmac_f32 v26, v46, v46
  v_fmac_f32 v26, v47, v47
  s_waitcnt vmcnt(3)
  s_mov_b32 s88, 147456
  buffer_load_dwordx4 v[216:219], v32, s[48:51], s88 offen nt
  v_add_f32_dpp v26, v26, v26 quad_perm:[1,0,3,2] row_mask:0xf bank_mask:0xf
  s_nop 1
  v_add_f32_dpp v26, v26, v26 quad_perm:[2,3,0,1] row_mask:0xf bank_mask:0xf
  s_nop 1
  v_add_f32_dpp v26, v26, v26 row_half_mirror row_mask:0xf bank_mask:0xf
  s_nop 1
  v_add_f32_dpp v26, v26, v26 row_mirror row_mask:0xf bank_mask:0xf
  s_nop 1
  v_add_f32_dpp v26, v26, v26 row_bcast:15 row_mask:0xa bank_mask:0xf
  s_nop 1
  v_add_f32_dpp v26, v26, v26 row_bcast:31 row_mask:0xc bank_mask:0xf
  s_nop 0
  v_readlane_b32 s89, v26, 63
  s_nop 1
  v_mov_b32 v28, s89
  v_mul_f32 v28, 0x3b000000, v28
  v_cvt_pk_bf16_f32 v29, v27, v28
  v_lshlrev_b32 v27, 16, v29
  v_and_b32 v28, 0xffff0000, v29
  v_add_f32 v28, 0x37280000, v28
  v_cvt_pk_bf16_f32 v28, v28, v28
  v_lshlrev_b32 v28, 16, v28
  v_sqrt_f32 v28, v28
  v_lshlrev_b32 v24, 16, v24
  v_lshlrev_b32 v25, 16, v25
  v_cvt_pk_bf16_f32 v28, v28, v28
  v_lshlrev_b32 v28, 16, v28
  v_rcp_f32 v28, v28
  v_sub_f32 v24, v24, v27
  v_sub_f32 v25, v25, v27
  v_cvt_pk_bf16_f32 v29, v24, v25
  v_lshlrev_b32 v24, 16, v29
  v_and_b32 v25, 0xffff0000, v29
  v_mul_f32 v24, v24, v28
  v_mul_f32 v25, v25, v28
  v_cvt_pk_bf16_f32 v24, v24, v24
  v_cvt_pk_bf16_f32 v25, v25, v25
  s_nop 0
  v_and_b32_dpp v12, v24, v8 row_newbcast:0 row_mask:0xf bank_mask:0xf
  v_and_b32_dpp v13, v24, v9 row_newbcast:0 row_mask:0xf bank_mask:0xf
  v_and_b32_dpp v14, v24, v10 row_newbcast:0 row_mask:0xf bank_mask:0xf
  v_and_b32_dpp v15, v24, v11 row_newbcast:0 row_mask:0xf bank_mask:0xf
  s_waitcnt vmcnt(3)
  s_mov_b32 s88, 155648
  buffer_load_dwordx4 v[220:223], v32, s[48:51], s88 offen nt
  s_waitcnt vmcnt(7)
  v_mfma_f32_16x16x32_bf16 v[20:23], v[12:15], v[192:195], 0
  v_and_b32_dpp v16, v24, v8 row_newbcast:1 row_mask:0xf bank_mask:0xf
  v_and_b32_dpp v17, v24, v9 row_newbcast:1 row_mask:0xf bank_mask:0xf
  v_and_b32_dpp v18, v24, v10 row_newbcast:1 row_mask:0xf bank_mask:0xf
  v_and_b32_dpp v19, v24, v11 row_newbcast:1 row_mask:0xf bank_mask:0xf
  s_waitcnt vmcnt(3)
  s_mov_b32 s88, 262144
  buffer_load_dwordx4 v[224:227], v32, s[48:51], s88 offen nt
  s_waitcnt vmcnt(7)
  v_mfma_f32_16x16x32_bf16 v[20:23], v[16:19], v[196:199], v[20:23]
  v_and_b32_dpp v12, v24, v8 row_newbcast:2 row_mask:0xf bank_mask:0xf
  v_and_b32_dpp v13, v24, v9 row_newbcast:2 row_mask:0xf bank_mask:0xf
  v_and_b32_dpp v14, v24, v10 row_newbcast:2 row_mask:0xf bank_mask:0xf
  v_and_b32_dpp v15, v24, v11 row_newbcast:2 row_mask:0xf bank_mask:0xf
  s_waitcnt vmcnt(3)
  s_mov_b32 s88, 270336
  buffer_load_dwordx4 v[228:231], v32, s[48:51], s88 offen nt
  s_waitcnt vmcnt(7)
  v_mfma_f32_16x16x32_bf16 v[20:23], v[12:15], v[200:203], v[20:23]
  v_and_b32_dpp v16, v24, v8 row_newbcast:3 row_mask:0xf bank_mask:0xf
  v_and_b32_dpp v17, v24, v9 row_newbcast:3 row_mask:0xf bank_mask:0xf
  v_and_b32_dpp v18, v24, v10 row_newbcast:3 row_mask:0xf bank_mask:0xf
  v_and_b32_dpp v19, v24, v11 row_newbcast:3 row_mask:0xf bank_mask:0xf
  s_waitcnt vmcnt(3)
  s_mov_b32 s88, 278528
  buffer_load_dwordx4 v[232:235], v32, s[48:51], s88 offen nt
  s_waitcnt vmcnt(7)
  v_mfma_f32_16x16x32_bf16 v[20:23], v[16:19], v[204:207], v[20:23]
  v_and_b32_dpp v12, v24, v8 row_newbcast:4 row_mask:0xf bank_mask:0xf
  v_and_b32_dpp v13, v24, v9 row_newbcast:4 row_mask:0xf bank_mask:0xf
  v_and_b32_dpp v14, v24, v10 row_newbcast:4 row_mask:0xf bank_mask:0xf
  v_and_b32_dpp v15, v24, v11 row_newbcast:4 row_mask:0xf bank_mask:0xf
  s_waitcnt vmcnt(3)
  s_mov_b32 s88, 286720
  buffer_load_dwordx4 v[236:239], v32, s[48:51], s88 offen nt
  s_waitcnt vmcnt(7)
  v_mfma_f32_16x16x32_bf16 v[20:23], v[12:15], v[208:211], v[20:23]
  v_and_b32_dpp v16, v24, v8 row_newbcast:5 row_mask:0xf bank_mask:0xf
  v_and_b32_dpp v17, v24, v9 row_newbcast:5 row_mask:0xf bank_mask:0xf
  v_and_b32_dpp v18, v24, v10 row_newbcast:5 row_mask:0xf bank_mask:0xf
  v_and_b32_dpp v19, v24, v11 row_newbcast:5 row_mask:0xf bank_mask:0xf
  s_waitcnt vmcnt(3)
  s_mov_b32 s88, 393216
  buffer_load_dwordx4 v[240:243], v32, s[48:51], s88 offen nt
  s_waitcnt vmcnt(7)
  v_mfma_f32_16x16x32_bf16 v[20:23], v[16:19], v[212:215], v[20:23]
  v_and_b32_dpp v12, v24, v8 row_newbcast:6 row_mask:0xf bank_mask:0xf
  v_and_b32_dpp v13, v24, v9 row_newbcast:6 row_mask:0xf bank_mask:0xf
  v_and_b32_dpp v14, v24, v10 row_newbcast:6 row_mask:0xf bank_mask:0xf
  v_and_b32_dpp v15, v24, v11 row_newbcast:6 row_mask:0xf bank_mask:0xf
  s_waitcnt vmcnt(3)
  s_mov_b32 s88, 401408
  buffer_load_dwordx4 v[244:247], v32, s[48:51], s88 offen nt
  s_waitcnt vmcnt(7)
  v_mfma_f32_16x16x32_bf16 v[20:23], v[12:15], v[216:219], v[20:23]
  v_and_b32_dpp v16, v24, v8 row_newbcast:7 row_mask:0xf bank_mask:0xf
  v_and_b32_dpp v17, v24, v9 row_newbcast:7 row_mask:0xf bank_mask:0xf
  v_and_b32_dpp v18, v24, v10 row_newbcast:7 row_mask:0xf bank_mask:0xf
  v_and_b32_dpp v19, v24, v11 row_newbcast:7 row_mask:0xf bank_mask:0xf
  s_waitcnt vmcnt(3)
  s_mov_b32 s88, 409600
  buffer_load_dwordx4 v[248:251], v32, s[48:51], s88 offen nt
  s_waitcnt vmcnt(7)
  v_mfma_f32_16x16x32_bf16 v[20:23], v[16:19], v[220:223], v[20:23]
  v_and_b32_dpp v12, v24, v8 row_newbcast:8 row_mask:0xf bank_mask:0xf
  v_and_b32_dpp v13, v24, v9 row_newbcast:8 row_mask:0xf bank_mask:0xf
  v_and_b32_dpp v14, v24, v10 row_newbcast:8 row_mask:0xf bank_mask:0xf
  v_and_b32_dpp v15, v24, v11 row_newbcast:8 row_mask:0xf bank_mask:0xf
  s_waitcnt vmcnt(3)
  s_mov_b32 s88, 417792
  buffer_load_dwordx4 v[252:255], v32, s[48:51], s88 offen nt
  s_waitcnt vmcnt(7)
  v_mfma_f32_16x16x32_bf16 v[20:23], v[12:15], v[224:227], v[20:23]
  v_and_b32_dpp v16, v24, v8 row_newbcast:9 row_mask:0xf bank_mask:0xf
  v_and_b32_dpp v17, v24, v9 row_newbcast:9 row_mask:0xf bank_mask:0xf
  v_and_b32_dpp v18, v24, v10 row_newbcast:9 row_mask:0xf bank_mask:0xf
  v_and_b32_dpp v19, v24, v11 row_newbcast:9 row_mask:0xf bank_mask:0xf
  s_waitcnt vmcnt(3)
  s_mov_b32 s88, 524288
  buffer_load_dwordx4 v[192:195], v32, s[48:51], s88 offen nt
  s_waitcnt vmcnt(7)
  v_mfma_f32_16x16x32_bf16 v[20:23], v[16:19], v[228:231], v[20:23]
  v_and_b32_dpp v12, v24, v8 row_newbcast:10 row_mask:0xf bank_mask:0xf
  v_and_b32_dpp v13, v24, v9 row_newbcast:10 row_mask:0xf bank_mask:0xf
  v_and_b32_dpp v14, v24, v10 row_newbcast:10 row_mask:0xf bank_mask:0xf
  v_and_b32_dpp v15, v24, v11 row_newbcast:10 row_mask:0xf bank_mask:0xf
  s_waitcnt vmcnt(3)
  s_mov_b32 s88, 532480
  buffer_load_dwordx4 v[196:199], v32, s[48:51], s88 offen nt
  s_waitcnt vmcnt(7)
  v_mfma_f32_16x16x32_bf16 v[20:23], v[12:15], v[232:235], v[20:23]
  v_and_b32_dpp v16, v24, v8 row_newbcast:11 row_mask:0xf bank_mask:0xf
  v_and_b32_dpp v17, v24, v9 row_newbcast:11 row_mask:0xf bank_mask:0xf
  v_and_b32_dpp v18, v24, v10 row_newbcast:11 row_mask:0xf bank_mask:0xf
  v_and_b32_dpp v19, v24, v11 row_newbcast:11 row_mask:0xf bank_mask:0xf
  s_waitcnt vmcnt(3)
  s_mov_b32 s88, 540672
  buffer_load_dwordx4 v[200:203], v32, s[48:51], s88 offen nt
  s_waitcnt vmcnt(7)
  v_mfma_f32_16x16x32_bf16 v[20:23], v[16:19], v[236:239], v[20:23]
  v_and_b32_dpp v12, v24, v8 row_newbcast:12 row_mask:0xf bank_mask:0xf
  v_and_b32_dpp v13, v24, v9 row_newbcast:12 row_mask:0xf bank_mask:0xf
  v_and_b32_dpp v14, v24, v10 row_newbcast:12 row_mask:0xf bank_mask:0xf
  v_and_b32_dpp v15, v24, v11 row_newbcast:12 row_mask:0xf bank_mask:0xf
  s_waitcnt vmcnt(3)
  s_mov_b32 s88, 548864
  buffer_load_dwordx4 v[204:207], v32, s[48:51], s88 offen nt
  s_waitcnt vmcnt(7)
  v_mfma_f32_16x16x32_bf16 v[20:23], v[12:15], v[240:243], v[20:23]
  v_and_b32_dpp v16, v24, v8 row_newbcast:13 row_mask:0xf bank_mask:0xf
  v_and_b32_dpp v17, v24, v9 row_newbcast:13 row_mask:0xf bank_mask:0xf
  v_and_b32_dpp v18, v24, v10 row_newbcast:13 row_mask:0xf bank_mask:0xf
  v_and_b32_dpp v19, v24, v11 row_newbcast:13 row_mask:0xf bank_mask:0xf
  s_waitcnt vmcnt(3)
  s_mov_b32 s88, 655360
  buffer_load_dwordx4 v[208:211], v32, s[48:51], s88 offen nt
  s_waitcnt vmcnt(7)
  v_mfma_f32_16x16x32_bf16 v[20:23], v[16:19], v[244:247], v[20:23]
  v_and_b32_dpp v12, v24, v8 row_newbcast:14 row_mask:0xf bank_mask:0xf
  v_and_b32_dpp v13, v24, v9 row_newbcast:14 row_mask:0xf bank_mask:0xf
  v_and_b32_dpp v14, v24, v10 row_newbcast:14 row_mask:0xf bank_mask:0xf
  v_and_b32_dpp v15, v24, v11 row_newbcast:14 row_mask:0xf bank_mask:0xf
  s_waitcnt vmcnt(3)
  s_mov_b32 s88, 663552
  buffer_load_dwordx4 v[212:215], v32, s[48:51], s88 offen nt
  s_waitcnt vmcnt(7)
  v_mfma_f32_16x16x32_bf16 v[20:23], v[12:15], v[248:251], v[20:23]
  v_and_b32_dpp v16, v24, v8 row_newbcast:15 row_mask:0xf bank_mask:0xf
  v_and_b32_dpp v17, v24, v9 row_newbcast:15 row_mask:0xf bank_mask:0xf
  v_and_b32_dpp v18, v24, v10 row_newbcast:15 row_mask:0xf bank_mask:0xf
  v_and_b32_dpp v19, v24, v11 row_newbcast:15 row_mask:0xf bank_mask:0xf
  s_waitcnt vmcnt(3)
  s_mov_b32 s88, 671744
  buffer_load_dwordx4 v[216:219], v32, s[48:51], s88 offen nt
  s_waitcnt vmcnt(7)
  v_mfma_f32_16x16x32_bf16 v[20:23], v[16:19], v[252:255], v[20:23]
  v_and_b32_dpp v12, v25, v8 row_newbcast:0 row_mask:0xf bank_mask:0xf
  v_and_b32_dpp v13, v25, v9 row_newbcast:0 row_mask:0xf bank_mask:0xf
  v_and_b32_dpp v14, v25, v10 row_newbcast:0 row_mask:0xf bank_mask:0xf
  v_and_b32_dpp v15, v25, v11 row_newbcast:0 row_mask:0xf bank_mask:0xf
  s_waitcnt vmcnt(3)
  s_mov_b32 s88, 679936
  buffer_load_dwordx4 v[220:223], v32, s[48:51], s88 offen nt
  s_waitcnt vmcnt(7)
  v_mfma_f32_16x16x32_bf16 v[20:23], v[12:15], v[192:195], v[20:23]
  v_and_b32_dpp v16, v25, v8 row_newbcast:1 row_mask:0xf bank_mask:0xf
  v_and_b32_dpp v17, v25, v9 row_newbcast:1 row_mask:0xf bank_mask:0xf
  v_and_b32_dpp v18, v25, v10 row_newbcast:1 row_mask:0xf bank_mask:0xf
  v_and_b32_dpp v19, v25, v11 row_newbcast:1 row_mask:0xf bank_mask:0xf
  s_waitcnt vmcnt(3)
  s_mov_b32 s88, 786432
  buffer_load_dwordx4 v[224:227], v32, s[48:51], s88 offen nt
  s_waitcnt vmcnt(7)
  v_mfma_f32_16x16x32_bf16 v[20:23], v[16:19], v[196:199], v[20:23]
  v_and_b32_dpp v12, v25, v8 row_newbcast:2 row_mask:0xf bank_mask:0xf
  v_and_b32_dpp v13, v25, v9 row_newbcast:2 row_mask:0xf bank_mask:0xf
  v_and_b32_dpp v14, v25, v10 row_newbcast:2 row_mask:0xf bank_mask:0xf
  v_and_b32_dpp v15, v25, v11 row_newbcast:2 row_mask:0xf bank_mask:0xf
  s_waitcnt vmcnt(3)
  s_mov_b32 s88, 794624
  buffer_load_dwordx4 v[228:231], v32, s[48:51], s88 offen nt
  s_waitcnt vmcnt(7)
  v_mfma_f32_16x16x32_bf16 v[20:23], v[12:15], v[200:203], v[20:23]
  v_and_b32_dpp v16, v25, v8 row_newbcast:3 row_mask:0xf bank_mask:0xf
  v_and_b32_dpp v17, v25, v9 row_newbcast:3 row_mask:0xf bank_mask:0xf
  v_and_b32_dpp v18, v25, v10 row_newbcast:3 row_mask:0xf bank_mask:0xf
  v_and_b32_dpp v19, v25, v11 row_newbcast:3 row_mask:0xf bank_mask:0xf
  s_waitcnt vmcnt(3)
  s_mov_b32 s88, 802816
  buffer_load_dwordx4 v[232:235], v32, s[48:51], s88 offen nt
  s_waitcnt vmcnt(7)
  v_mfma_f32_16x16x32_bf16 v[20:23], v[16:19], v[204:207], v[20:23]
  v_and_b32_dpp v12, v25, v8 row_newbcast:4 row_mask:0xf bank_mask:0xf
  v_and_b32_dpp v13, v25, v9 row_newbcast:4 row_mask:0xf bank_mask:0xf
  v_and_b32_dpp v14, v25, v10 row_newbcast:4 row_mask:0xf bank_mask:0xf
  v_and_b32_dpp v15, v25, v11 row_newbcast:4 row_mask:0xf bank_mask:0xf
  s_waitcnt vmcnt(3)
  s_mov_b32 s88, 811008
  buffer_load_dwordx4 v[236:239], v32, s[48:51], s88 offen nt
  s_waitcnt vmcnt(7)
  v_mfma_f32_16x16x32_bf16 v[20:23], v[12:15], v[208:211], v[20:23]
  v_and_b32_dpp v16, v25, v8 row_newbcast:5 row_mask:0xf bank_mask:0xf
  v_and_b32_dpp v17, v25, v9 row_newbcast:5 row_mask:0xf bank_mask:0xf
  v_and_b32_dpp v18, v25, v10 row_newbcast:5 row_mask:0xf bank_mask:0xf
  v_and_b32_dpp v19, v25, v11 row_newbcast:5 row_mask:0xf bank_mask:0xf
  s_waitcnt vmcnt(3)
  s_mov_b32 s88, 917504
  buffer_load_dwordx4 v[240:243], v32, s[48:51], s88 offen nt
  s_waitcnt vmcnt(7)
  v_mfma_f32_16x16x32_bf16 v[20:23], v[16:19], v[212:215], v[20:23]
  v_and_b32_dpp v12, v25, v8 row_newbcast:6 row_mask:0xf bank_mask:0xf
  v_and_b32_dpp v13, v25, v9 row_newbcast:6 row_mask:0xf bank_mask:0xf
  v_and_b32_dpp v14, v25, v10 row_newbcast:6 row_mask:0xf bank_mask:0xf
  v_and_b32_dpp v15, v25, v11 row_newbcast:6 row_mask:0xf bank_mask:0xf
  s_waitcnt vmcnt(3)
  s_mov_b32 s88, 925696
  buffer_load_dwordx4 v[244:247], v32, s[48:51], s88 offen nt
  s_waitcnt vmcnt(7)
  v_mfma_f32_16x16x32_bf16 v[20:23], v[12:15], v[216:219], v[20:23]
  v_and_b32_dpp v16, v25, v8 row_newbcast:7 row_mask:0xf bank_mask:0xf
  v_and_b32_dpp v17, v25, v9 row_newbcast:7 row_mask:0xf bank_mask:0xf
  v_and_b32_dpp v18, v25, v10 row_newbcast:7 row_mask:0xf bank_mask:0xf
  v_and_b32_dpp v19, v25, v11 row_newbcast:7 row_mask:0xf bank_mask:0xf
  s_waitcnt vmcnt(3)
  s_mov_b32 s88, 933888
  buffer_load_dwordx4 v[248:251], v32, s[48:51], s88 offen nt
  s_waitcnt vmcnt(7)
  v_mfma_f32_16x16x32_bf16 v[20:23], v[16:19], v[220:223], v[20:23]
  v_and_b32_dpp v12, v25, v8 row_newbcast:8 row_mask:0xf bank_mask:0xf
  v_and_b32_dpp v13, v25, v9 row_newbcast:8 row_mask:0xf bank_mask:0xf
  v_and_b32_dpp v14, v25, v10 row_newbcast:8 row_mask:0xf bank_mask:0xf
  v_and_b32_dpp v15, v25, v11 row_newbcast:8 row_mask:0xf bank_mask:0xf
  s_waitcnt vmcnt(3)
  s_mov_b32 s88, 942080
  buffer_load_dwordx4 v[252:255], v32, s[48:51], s88 offen nt
  s_waitcnt vmcnt(7)
  v_mfma_f32_16x16x32_bf16 v[20:23], v[12:15], v[224:227], v[20:23]
  v_and_b32_dpp v16, v25, v8 row_newbcast:9 row_mask:0xf bank_mask:0xf
  v_and_b32_dpp v17, v25, v9 row_newbcast:9 row_mask:0xf bank_mask:0xf
  v_and_b32_dpp v18, v25, v10 row_newbcast:9 row_mask:0xf bank_mask:0xf
  v_and_b32_dpp v19, v25, v11 row_newbcast:9 row_mask:0xf bank_mask:0xf
  s_waitcnt vmcnt(6)
  s_nop 0
  v_mfma_f32_16x16x32_bf16 v[20:23], v[16:19], v[228:231], v[20:23]
  v_and_b32_dpp v12, v25, v8 row_newbcast:10 row_mask:0xf bank_mask:0xf
  v_and_b32_dpp v13, v25, v9 row_newbcast:10 row_mask:0xf bank_mask:0xf
  v_and_b32_dpp v14, v25, v10 row_newbcast:10 row_mask:0xf bank_mask:0xf
  v_and_b32_dpp v15, v25, v11 row_newbcast:10 row_mask:0xf bank_mask:0xf
  s_waitcnt vmcnt(5)
  s_nop 0
  v_mfma_f32_16x16x32_bf16 v[20:23], v[12:15], v[232:235], v[20:23]
  v_and_b32_dpp v16, v25, v8 row_newbcast:11 row_mask:0xf bank_mask:0xf
  v_and_b32_dpp v17, v25, v9 row_newbcast:11 row_mask:0xf bank_mask:0xf
  v_and_b32_dpp v18, v25, v10 row_newbcast:11 row_mask:0xf bank_mask:0xf
  v_and_b32_dpp v19, v25, v11 row_newbcast:11 row_mask:0xf bank_mask:0xf
  s_waitcnt vmcnt(4)
  s_nop 0
  v_mfma_f32_16x16x32_bf16 v[20:23], v[16:19], v[236:239], v[20:23]
  v_and_b32_dpp v12, v25, v8 row_newbcast:12 row_mask:0xf bank_mask:0xf
  v_and_b32_dpp v13, v25, v9 row_newbcast:12 row_mask:0xf bank_mask:0xf
  v_and_b32_dpp v14, v25, v10 row_newbcast:12 row_mask:0xf bank_mask:0xf
  v_and_b32_dpp v15, v25, v11 row_newbcast:12 row_mask:0xf bank_mask:0xf
  s_waitcnt vmcnt(3)
  s_nop 0
  v_mfma_f32_16x16x32_bf16 v[20:23], v[12:15], v[240:243], v[20:23]
  v_and_b32_dpp v16, v25, v8 row_newbcast:13 row_mask:0xf bank_mask:0xf
  v_and_b32_dpp v17, v25, v9 row_newbcast:13 row_mask:0xf bank_mask:0xf
  v_and_b32_dpp v18, v25, v10 row_newbcast:13 row_mask:0xf bank_mask:0xf
  v_and_b32_dpp v19, v25, v11 row_newbcast:13 row_mask:0xf bank_mask:0xf
  s_waitcnt vmcnt(2)
  s_nop 0
  v_mfma_f32_16x16x32_bf16 v[20:23], v[16:19], v[244:247], v[20:23]
  v_and_b32_dpp v12, v25, v8 row_newbcast:14 row_mask:0xf bank_mask:0xf
  v_and_b32_dpp v13, v25, v9 row_newbcast:14 row_mask:0xf bank_mask:0xf
  v_and_b32_dpp v14, v25, v10 row_newbcast:14 row_mask:0xf bank_mask:0xf
  v_and_b32_dpp v15, v25, v11 row_newbcast:14 row_mask:0xf bank_mask:0xf
  s_waitcnt vmcnt(1)
  s_nop 0
  v_mfma_f32_16x16x32_bf16 v[20:23], v[12:15], v[248:251], v[20:23]
  v_and_b32_dpp v16, v25, v8 row_newbcast:15 row_mask:0xf bank_mask:0xf
  v_and_b32_dpp v17, v25, v9 row_newbcast:15 row_mask:0xf bank_mask:0xf
  v_and_b32_dpp v18, v25, v10 row_newbcast:15 row_mask:0xf bank_mask:0xf
  v_and_b32_dpp v19, v25, v11 row_newbcast:15 row_mask:0xf bank_mask:0xf
  s_waitcnt vmcnt(0)
  s_nop 0
  v_mfma_f32_16x16x32_bf16 v[20:23], v[16:19], v[252:255], v[20:23]
  s_lshl_b32 s88, s6, 9
  v_add_u32 v26, s88, v35
  s_mov_b32 exec_hi, 0
  s_nop 4
  ds_write_b128 v26, v[20:23] offset:0
  s_mov_b64 exec, -1
  s_waitcnt lgkmcnt(0)
  s_barrier
  s_cmp_lg_u32 s6, 0
  s_cbranch_scc1 L_noen
  buffer_load_dword v26, v60, s[80:83], 0 offen offset:128 sc1
  s_waitcnt vmcnt(0)
  v_readfirstlane_b32 s88, v26
  s_nop 0
  s_cmp_eq_u32 s88, 0
  s_cbranch_scc1 L_noen
  v_mov_b32 v26, 128
  ds_write_b32 v60, v26 offset:5192
L_noen:
  s_xor_b32 s88, s2, 29
  s_xor_b32 s89, s6, 1
  s_or_b32 s88, s88, s89
  s_cmp_lg_u32 s88, 0
  s_cbranch_scc1 L_rdy0_ok
  v_mov_b32 v27, 1
  s_mov_b64 exec, 1
  buffer_atomic_add v27, v60, s[80:83], 0 offen sc0
  s_mov_b64 exec, -1
  s_waitcnt vmcnt(0)
  v_readfirstlane_b32 s88, v27
  s_nop 0
  s_cmp_lg_u32 s88, 0
  s_cbranch_scc1 L_rdy0_ok
  v_mov_b32 v40, 0
  v_mov_b32 v41, 0
  v_mov_b32 v42, 0
  v_mov_b32 v43, 0
  v_lshlrev_b32 v27, 4, v1
  s_mov_b32 s88, 0
L_rdy0_init:
  buffer_store_dwordx4 v[40:43], v27, s[72:75], s88 offen sc1
  s_add_u32 s88, s88, 1024
  s_cmp_lt_u32 s88, 21504
  s_cbranch_scc1 L_rdy0_init
  s_waitcnt vmcnt(0)
  v_mov_b32 v27, 1
  s_mov_b64 exec, 1
  buffer_atomic_add v27, v60, s[80:83], 0 offen offset:64
  s_mov_b64 exec, -1
L_rdy0_ok:
  v_and_b32 v26, 1, v2
  v_lshlrev_b32 v26, 3, v26
  v_lshl_add_u32 v26, v3, 4, v26
  s_lshl_b32 s88, s6, 8
  v_add_u32 v50, s88, v26
  v_add_u32 v51, s84, v50
  buffer_load_dwordx2 v[52:53], v51, s[44:47], 0 offen
  buffer_load_dwordx2 v[48:49], v50, s[68:71], 0 offen
  s_lshl_b32 s88, s5, 7
  v_lshl_add_u32 v54, v2, 4, s88
  v_lshlrev_b32 v54, 10, v54
  v_lshl_add_u32 v54, v3, 4, v54
  s_lshl_b32 s88, s6, 8
  v_add_u32 v54, s88, v54
  v_and_b32 v55, 31, v1
  v_lshlrev_b32 v55, 2, v55
  s_lshl_b32 s88, s6, 9
  v_add_u32 v55, s88, v55
  v_lshl_add_u32 v35, v26, 1, s88
  s_lshl_b32 s88, s4, 2
  s_add_u32 s88, s88, s6
  s_lshl_b32 s89, s5, 17
  s_lshl_b32 s90, s88, 12
  s_add_u32 s89, s89, s90
  s_add_u32 s12, s24, s89
  s_addc_u32 s13, s25, 0
  s_load_dword s11, s[12:13], 0
  s_load_dword s11, s[12:13], 64
  s_load_dword s11, s[12:13], 128
  s_load_dword s11, s[12:13], 192
  s_load_dword s11, s[12:13], 256
  s_load_dword s11, s[12:13], 320
  s_load_dword s11, s[12:13], 384
  s_load_dword s11, s[12:13], 448
  s_load_dword s11, s[12:13], 512
  s_load_dword s11, s[12:13], 576
  s_load_dword s11, s[12:13], 640
  s_load_dword s11, s[12:13], 704
  s_load_dword s11, s[12:13], 768
  s_load_dword s11, s[12:13], 832
  s_load_dword s11, s[12:13], 896
  s_load_dword s11, s[12:13], 960
  s_waitcnt lgkmcnt(0)
  s_load_dword s11, s[12:13], 1024
  s_load_dword s11, s[12:13], 1088
  s_load_dword s11, s[12:13], 1152
  s_load_dword s11, s[12:13], 1216
  s_load_dword s11, s[12:13], 1280
  s_load_dword s11, s[12:13], 1344
  s_load_dword s11, s[12:13], 1408
  s_load_dword s11, s[12:13], 1472
  s_load_dword s11, s[12:13], 1536
  s_load_dword s11, s[12:13], 1600
  s_load_dword s11, s[12:13], 1664
  s_load_dword s11, s[12:13], 1728
  s_load_dword s11, s[12:13], 1792
  s_load_dword s11, s[12:13], 1856
  s_load_dword s11, s[12:13], 1920
  s_load_dword s11, s[12:13], 1984
  s_waitcnt lgkmcnt(0)
  s_load_dword s11, s[12:13], 2048
  s_load_dword s11, s[12:13], 2112
  s_load_dword s11, s[12:13], 2176
  s_load_dword s11, s[12:13], 2240
  s_load_dword s11, s[12:13], 2304
  s_load_dword s11, s[12:13], 2368
  s_load_dword s11, s[12:13], 2432
  s_load_dword s11, s[12:13], 2496
  s_load_dword s11, s[12:13], 2560
  s_load_dword s11, s[12:13], 2624
  s_load_dword s11, s[12:13], 2688
  s_load_dword s11, s[12:13], 2752
  s_load_dword s11, s[12:13], 2816
  s_load_dword s11, s[12:13], 2880
  s_load_dword s11, s[12:13], 2944
  s_load_dword s11, s[12:13], 3008
  s_waitcnt lgkmcnt(0)
  s_load_dword s11, s[12:13], 3072
  s_load_dword s11, s[12:13], 3136
  s_load_dword s11, s[12:13], 3200
  s_load_dword s11, s[12:13], 3264
  s_load_dword s11, s[12:13], 3328
  s_load_dword s11, s[12:13], 3392
  s_load_dword s11, s[12:13], 3456
  s_load_dword s11, s[12:13], 3520
  s_load_dword s11, s[12:13], 3584
  s_load_dword s11, s[12:13], 3648
  s_load_dword s11, s[12:13], 3712
  s_load_dword s11, s[12:13], 3776
  s_load_dword s11, s[12:13], 3840
  s_load_dword s11, s[12:13], 3904
  s_load_dword s11, s[12:13], 3968
  s_load_dword s11, s[12:13], 4032
  s_waitcnt lgkmcnt(0)
  s_cmp_ge_u32 s5, 28
  s_cbranch_scc1 L_nospf
  s_lshl_b32 s89, s5, 16
  s_lshl_b32 s90, s88, 11
  s_add_u32 s89, s89, s90
  s_add_u32 s12, s32, s89
  s_addc_u32 s13, s33, 0
  s_mul_i32 s89, s88, 57344
  s_lshl_b32 s90, s5, 7
  s_add_u32 s89, s89, s90
  s_add_u32 s14, s28, s89
  s_addc_u32 s15, s29, 0
  s_load_dword s11, s[14:15], 0
  s_load_dword s11, s[14:15], 64
  s_load_dword s11, s[14:15], 3584
  s_load_dword s11, s[14:15], 3648
  s_load_dword s11, s[14:15], 7168
  s_load_dword s11, s[14:15], 7232
  s_load_dword s11, s[14:15], 10752
  s_load_dword s11, s[14:15], 10816
  s_load_dword s11, s[14:15], 14336
  s_load_dword s11, s[14:15], 14400
  s_load_dword s11, s[14:15], 17920
  s_load_dword s11, s[14:15], 17984
  s_load_dword s11, s[14:15], 21504
  s_load_dword s11, s[14:15], 21568
  s_load_dword s11, s[14:15], 25088
  s_load_dword s11, s[14:15], 25152
  s_waitcnt lgkmcnt(0)
  s_load_dword s11, s[14:15], 28672
  s_load_dword s11, s[14:15], 28736
  s_load_dword s11, s[14:15], 32256
  s_load_dword s11, s[14:15], 32320
  s_load_dword s11, s[14:15], 35840
  s_load_dword s11, s[14:15], 35904
  s_load_dword s11, s[14:15], 39424
  s_load_dword s11, s[14:15], 39488
  s_load_dword s11, s[14:15], 43008
  s_load_dword s11, s[14:15], 43072
  s_load_dword s11, s[14:15], 46592
  s_load_dword s11, s[14:15], 46656
  s_load_dword s11, s[14:15], 50176
  s_load_dword s11, s[14:15], 50240
  s_load_dword s11, s[14:15], 53760
  s_load_dword s11, s[14:15], 53824
  s_waitcnt lgkmcnt(0)
  s_load_dword s11, s[12:13], 0
  s_load_dword s11, s[12:13], 64
  s_load_dword s11, s[12:13], 128
  s_load_dword s11, s[12:13], 192
  s_load_dword s11, s[12:13], 256
  s_load_dword s11, s[12:13], 320
  s_load_dword s11, s[12:13], 384
  s_load_dword s11, s[12:13], 448
  s_load_dword s11, s[12:13], 512
  s_load_dword s11, s[12:13], 576
  s_load_dword s11, s[12:13], 640
  s_load_dword s11, s[12:13], 704
  s_load_dword s11, s[12:13], 768
  s_load_dword s11, s[12:13], 832
  s_load_dword s11, s[12:13], 896
  s_load_dword s11, s[12:13], 960
  s_waitcnt lgkmcnt(0)
  s_load_dword s11, s[12:13], 1024
  s_load_dword s11, s[12:13], 1088
  s_load_dword s11, s[12:13], 1152
  s_load_dword s11, s[12:13], 1216
  s_load_dword s11, s[12:13], 1280
  s_load_dword s11, s[12:13], 1344
  s_load_dword s11, s[12:13], 1408
  s_load_dword s11, s[12:13], 1472
  s_load_dword s11, s[12:13], 1536
  s_load_dword s11, s[12:13], 1600
  s_load_dword s11, s[12:13], 1664
  s_load_dword s11, s[12:13], 1728
  s_load_dword s11, s[12:13], 1792
  s_load_dword s11, s[12:13], 1856
  s_load_dword s11, s[12:13], 1920
  s_load_dword s11, s[12:13], 1984
  s_waitcnt lgkmcnt(0)
L_nospf:
  s_waitcnt lgkmcnt(0)
  s_waitcnt vmcnt(1)
  s_mov_b32 s88, 0
  buffer_load_dwordx4 v[64:67], v54, s[60:63], s88 offen nt
  s_waitcnt vmcnt(1)
  s_mov_b32 s88, 1024
  buffer_load_dwordx4 v[68:71], v54, s[60:63], s88 offen nt
  s_waitcnt vmcnt(1)
  s_mov_b32 s88, 2048
  buffer_load_dwordx4 v[72:75], v54, s[60:63], s88 offen nt
  s_waitcnt vmcnt(1)
  s_mov_b32 s88, 3072
  buffer_load_dwordx4 v[76:79], v54, s[60:63], s88 offen nt
  s_waitcnt vmcnt(1)
  s_mov_b32 s88, 4096
  buffer_load_dwordx4 v[80:83], v54, s[60:63], s88 offen nt
  s_waitcnt vmcnt(1)
  s_mov_b32 s88, 5120
  buffer_load_dwordx4 v[84:87], v54, s[60:63], s88 offen nt
  s_waitcnt vmcnt(1)
  s_mov_b32 s88, 6144
  buffer_load_dwordx4 v[88:91], v54, s[60:63], s88 offen nt
  s_waitcnt vmcnt(1)
  s_mov_b32 s88, 7168
  buffer_load_dwordx4 v[92:95], v54, s[60:63], s88 offen nt
  s_waitcnt vmcnt(1)
  s_mov_b32 s88, 8192
  buffer_load_dwordx4 v[96:99], v54, s[60:63], s88 offen nt
  s_waitcnt vmcnt(1)
  s_mov_b32 s88, 9216
  buffer_load_dwordx4 v[100:103], v54, s[60:63], s88 offen nt
  s_waitcnt vmcnt(1)
  s_mov_b32 s88, 10240
  buffer_load_dwordx4 v[104:107], v54, s[60:63], s88 offen nt
  s_waitcnt vmcnt(1)
  s_mov_b32 s88, 11264
  buffer_load_dwordx4 v[108:111], v54, s[60:63], s88 offen nt
  s_waitcnt vmcnt(1)
  s_mov_b32 s88, 12288
  buffer_load_dwordx4 v[112:115], v54, s[60:63], s88 offen nt
  s_waitcnt vmcnt(1)
  s_mov_b32 s88, 13312
  buffer_load_dwordx4 v[116:119], v54, s[60:63], s88 offen nt
  s_waitcnt vmcnt(1)
  s_mov_b32 s88, 14336
  buffer_load_dwordx4 v[120:123], v54, s[60:63], s88 offen nt
  s_waitcnt vmcnt(1)
  s_mov_b32 s88, 15360
  buffer_load_dwordx4 v[124:127], v54, s[60:63], s88 offen nt
  s_waitcnt vmcnt(1)
  s_mov_b32 s88, 65536
  buffer_load_dwordx4 v[128:131], v54, s[60:63], s88 offen nt
  s_waitcnt vmcnt(1)
  s_mov_b32 s88, 66560
  buffer_load_dwordx4 v[132:135], v54, s[60:63], s88 offen nt
  s_waitcnt vmcnt(1)
  s_mov_b32 s88, 67584
  buffer_load_dwordx4 v[136:139], v54, s[60:63], s88 offen nt
  s_waitcnt vmcnt(1)
  s_mov_b32 s88, 68608
  buffer_load_dwordx4 v[140:143], v54, s[60:63], s88 offen nt
  s_waitcnt vmcnt(1)
  s_mov_b32 s88, 69632
  buffer_load_dwordx4 v[144:147], v54, s[60:63], s88 offen nt
  s_waitcnt vmcnt(1)
  s_mov_b32 s88, 70656
  buffer_load_dwordx4 v[148:151], v54, s[60:63], s88 offen nt
  s_waitcnt vmcnt(1)
  s_mov_b32 s88, 71680
  buffer_load_dwordx4 v[152:155], v54, s[60:63], s88 offen nt
  s_waitcnt vmcnt(1)
  s_mov_b32 s88, 72704
  buffer_load_dwordx4 v[156:159], v54, s[60:63], s88 offen nt
  s_waitcnt vmcnt(1)
  s_mov_b32 s88, 73728
  buffer_load_dwordx4 v[160:163], v54, s[60:63], s88 offen nt
  s_waitcnt vmcnt(1)
  s_mov_b32 s88, 74752
  buffer_load_dwordx4 v[164:167], v54, s[60:63], s88 offen nt
  s_waitcnt vmcnt(1)
  s_mov_b32 s88, 75776
  buffer_load_dwordx4 v[168:171], v54, s[60:63], s88 offen nt
  s_waitcnt vmcnt(1)
  s_mov_b32 s88, 76800
  buffer_load_dwordx4 v[172:175], v54, s[60:63], s88 offen nt
  s_waitcnt vmcnt(1)
  s_mov_b32 s88, 77824
  buffer_load_dwordx4 v[176:179], v54, s[60:63], s88 offen nt
  s_waitcnt vmcnt(1)
  s_mov_b32 s88, 78848
  buffer_load_dwordx4 v[180:183], v54, s[60:63], s88 offen nt
  s_waitcnt vmcnt(1)
  s_mov_b32 s88, 79872
  buffer_load_dwordx4 v[184:187], v54, s[60:63], s88 offen nt
  s_waitcnt vmcnt(1)
  s_mov_b32 s88, 80896
  buffer_load_dwordx4 v[188:191], v54, s[60:63], s88 offen nt
  s_mov_b32 s87, 0
L_rdy2_pat:
  buffer_load_dword v26, v60, s[80:83], 0 offen offset:64 sc1
  s_waitcnt vmcnt(0)
  v_readfirstlane_b32 s88, v26
  s_nop 0
  s_cmp_lg_u32 s88, 0
  s_cbranch_scc1 L_rdy2_ok
  s_sleep 100
  s_add_u32 s87, s87, 1
  s_cmp_lt_u32 s87, 8
  s_cbranch_scc1 L_rdy2_pat
  v_mov_b32 v27, 1
  s_mov_b64 exec, 1
  buffer_atomic_add v27, v60, s[80:83], 0 offen sc0
  s_mov_b64 exec, -1
  s_waitcnt vmcnt(0)
  v_readfirstlane_b32 s88, v27
  s_nop 0
  s_cmp_lg_u32 s88, 0
  s_cbranch_scc1 L_rdy2_spin
  v_mov_b32 v40, 0
  v_mov_b32 v41, 0
  v_mov_b32 v42, 0
  v_mov_b32 v43, 0
  v_lshlrev_b32 v27, 4, v1
  s_mov_b32 s88, 0
L_rdy2_init:
  buffer_store_dwordx4 v[40:43], v27, s[72:75], s88 offen sc1
  s_add_u32 s88, s88, 1024
  s_cmp_lt_u32 s88, 21504
  s_cbranch_scc1 L_rdy2_init
  s_waitcnt vmcnt(0)
  v_mov_b32 v27, 1
  s_mov_b64 exec, 1
  buffer_atomic_add v27, v60, s[80:83], 0 offen offset:64
  s_mov_b64 exec, -1
  s_branch L_rdy2_ok
L_rdy2_spin:
  s_mov_b32 s87, 0
L_rdy2_spin2:
  s_sleep 8
  buffer_load_dword v26, v60, s[80:83], 0 offen offset:64 sc1
  s_waitcnt vmcnt(0)
  v_readfirstlane_b32 s88, v26
  s_nop 0
  s_cmp_lg_u32 s88, 0
  s_cbranch_scc1 L_rdy2_ok
  s_add_u32 s87, s87, 1
  s_cmp_lt_u32 s87, 0x40000
  s_cbranch_scc1 L_rdy2_spin2
L_rdy2_ok:
  s_and_b32 s88, s5, 7
  s_cmp_lg_u32 s88, s4
  s_cbranch_scc1 L_noffn
  s_cmp_ge_u32 s5, 28
  s_cbranch_scc1 L_noffn
  v_and_b32 v26, 1, v3
  v_mov_b32 v27, 0xffff
  v_mov_b32 v28, 0xffff0000
  v_cmp_eq_u32 vcc, 1, v26
  v_bfe_u32 v29, v3, 1, 2
  s_nop 0
  v_cndmask_b32 v26, v27, v28, vcc
  v_cmp_eq_u32 vcc, 0, v29
  s_nop 1
  v_cndmask_b32 v4, 0, v26, vcc
  v_cmp_eq_u32 vcc, 1, v29
  s_nop 1
  v_cndmask_b32 v5, 0, v26, vcc
  v_cmp_eq_u32 vcc, 2, v29
  s_nop 1
  v_cndmask_b32 v6, 0, v26, vcc
  v_cmp_eq_u32 vcc, 3, v29
  s_nop 1
  v_cndmask_b32 v7, 0, v26, vcc
  v_lshrrev_b32 v26, 3, v3
  v_lshl_add_u32 v26, v26, 6, v33
  s_movk_i32 s88, 3584
  v_mul_lo_u32 v34, v26, s88
  v_and_b32 v26, 7, v3
  v_lshl_add_u32 v34, v26, 4, v34
  s_lshl_b32 s88, s5, 7
  v_add_u32 v34, s88, v34
  s_lshl_b32 s88, s5, 6
  v_lshl_add_u32 v61, v2, 4, s88
  v_lshlrev_b32 v61, 10, v61
  v_lshl_add_u32 v61, v3, 4, v61
  s_lshl_b32 s89, s6, 8
  v_add_u32 v61, s89, v61
  v_add_lshl_u32 v26, v1, s88, 1
  buffer_load_ushort v56, v26, s[64:67], 0 offen
  v_lshl_add_u32 v31, v1, 1, s89
  s_waitcnt vmcnt(1)
  s_mov_b32 s88, 0
  buffer_load_dwordx4 v[192:195], v34, s[52:55], s88 offen nt
  s_waitcnt vmcnt(1)
  s_mov_b32 s88, 3584
  buffer_load_dwordx4 v[196:199], v34, s[52:55], s88 offen nt
  s_waitcnt vmcnt(1)
  s_mov_b32 s88, 7168
  buffer_load_dwordx4 v[200:203], v34, s[52:55], s88 offen nt
  s_waitcnt vmcnt(1)
  s_mov_b32 s88, 10752
  buffer_load_dwordx4 v[204:207], v34, s[52:55], s88 offen nt
  s_waitcnt vmcnt(1)
  s_mov_b32 s88, 14336
  buffer_load_dwordx4 v[208:211], v34, s[52:55], s88 offen nt
  s_waitcnt vmcnt(1)
  s_mov_b32 s88, 17920
  buffer_load_dwordx4 v[212:215], v34, s[52:55], s88 offen nt
  s_waitcnt vmcnt(1)
  s_mov_b32 s88, 21504
  buffer_load_dwordx4 v[216:219], v34, s[52:55], s88 offen nt
  s_waitcnt vmcnt(1)
  s_mov_b32 s88, 25088
  buffer_load_dwordx4 v[220:223], v34, s[52:55], s88 offen nt
  s_waitcnt vmcnt(1)
  s_mov_b32 s88, 28672
  buffer_load_dwordx4 v[224:227], v34, s[52:55], s88 offen nt
  s_waitcnt vmcnt(1)
  s_mov_b32 s88, 32256
  buffer_load_dwordx4 v[228:231], v34, s[52:55], s88 offen nt
  s_waitcnt vmcnt(1)
  s_mov_b32 s88, 35840
  buffer_load_dwordx4 v[232:235], v34, s[52:55], s88 offen nt
  s_waitcnt vmcnt(1)
  s_mov_b32 s88, 39424
  buffer_load_dwordx4 v[236:239], v34, s[52:55], s88 offen nt
  s_waitcnt vmcnt(1)
  s_mov_b32 s88, 43008
  buffer_load_dwordx4 v[240:243], v34, s[52:55], s88 offen nt
  s_waitcnt vmcnt(1)
  s_mov_b32 s88, 46592
  buffer_load_dwordx4 v[244:247], v34, s[52:55], s88 offen nt
  s_waitcnt vmcnt(1)
  s_mov_b32 s88, 50176
  buffer_load_dwordx4 v[248:251], v34, s[52:55], s88 offen nt
  s_waitcnt vmcnt(1)
  s_mov_b32 s88, 53760
  buffer_load_dwordx4 v[252:255], v34, s[52:55], s88 offen nt
  v_lshrrev_b32 v26, 1, v2
  v_lshlrev_b32 v26, 8, v26
  v_and_b32 v27, 7, v3
  v_lshl_add_u32 v26, v27, 5, v26
  v_and_b32 v27, 1, v2
  v_lshl_add_u32 v26, v27, 4, v26
  s_lshl_b32 s88, s6, 9
  v_add_u32 v32, s88, v26
  s_mov_b32 s90, 0
L_ffn1:
  buffer_load_dwordx4 v[36:39], v30, s[44:47], s90 offen
  buffer_load_ushort v24, v31, s[44:47], s90 offen
  buffer_load_ushort v25, v31, s[44:47], s90 offen offset:128
  s_waitcnt vmcnt(0)
  v_lshlrev_b32 v40, 16, v36
  v_and_b32 v41, 0xffff0000, v36
  v_lshlrev_b32 v42, 16, v37
  v_and_b32 v43, 0xffff0000, v37
  v_lshlrev_b32 v44, 16, v38
  v_and_b32 v45, 0xffff0000, v38
  v_lshlrev_b32 v46, 16, v39
  v_and_b32 v47, 0xffff0000, v39
  v_add_f32 v26, v40, v41
  v_add_f32 v27, v42, v43
  v_add_f32 v28, v44, v45
  v_add_f32 v29, v46, v47
  v_add_f32 v26, v26, v27
  v_add_f32 v28, v28, v29
  v_add_f32 v26, v26, v28
  s_nop 1
  v_add_f32_dpp v26, v26, v26 quad_perm:[1,0,3,2] row_mask:0xf bank_mask:0xf
  s_nop 1
  v_add_f32_dpp v26, v26, v26 quad_perm:[2,3,0,1] row_mask:0xf bank_mask:0xf
  s_nop 1
  v_add_f32_dpp v26, v26, v26 row_half_mirror row_mask:0xf bank_mask:0xf
  s_nop 1
  v_add_f32_dpp v26, v26, v26 row_mirror row_mask:0xf bank_mask:0xf
  s_nop 1
  v_add_f32_dpp v26, v26, v26 row_bcast:15 row_mask:0xa bank_mask:0xf
  s_nop 1
  v_add_f32_dpp v26, v26, v26 row_bcast:31 row_mask:0xc bank_mask:0xf
  s_nop 0
  v_readlane_b32 s89, v26, 63
  s_nop 1
  v_mov_b32 v27, s89
  v_mul_f32 v27, 0x3b000000, v27
  v_sub_f32 v40, v40, v27
  v_sub_f32 v41, v41, v27
  v_sub_f32 v42, v42, v27
  v_sub_f32 v43, v43, v27
  v_sub_f32 v44, v44, v27
  v_sub_f32 v45, v45, v27
  v_sub_f32 v46, v46, v27
  v_sub_f32 v47, v47, v27
  v_mul_f32 v26, v40, v40
  v_fmac_f32 v26, v41, v41
  v_fmac_f32 v26, v42, v42
  v_fmac_f32 v26, v43, v43
  v_fmac_f32 v26, v44, v44
  v_fmac_f32 v26, v45, v45
  v_fmac_f32 v26, v46, v46
  v_fmac_f32 v26, v47, v47
  s_nop 1
  v_add_f32_dpp v26, v26, v26 quad_perm:[1,0,3,2] row_mask:0xf bank_mask:0xf
  s_nop 1
  v_add_f32_dpp v26, v26, v26 quad_perm:[2,3,0,1] row_mask:0xf bank_mask:0xf
  s_nop 1
  v_add_f32_dpp v26, v26, v26 row_half_mirror row_mask:0xf bank_mask:0xf
  s_nop 1
  v_add_f32_dpp v26, v26, v26 row_mirror row_mask:0xf bank_mask:0xf
  s_nop 1
  v_add_f32_dpp v26, v26, v26 row_bcast:15 row_mask:0xa bank_mask:0xf
  s_nop 1
  v_add_f32_dpp v26, v26, v26 row_bcast:31 row_mask:0xc bank_mask:0xf
  s_nop 0
  v_readlane_b32 s89, v26, 63
  s_nop 1
  v_mov_b32 v28, s89
  v_mul_f32 v28, 0x3b000000, v28
  v_cvt_pk_bf16_f32 v29, v27, v28
  v_lshlrev_b32 v27, 16, v29
  v_and_b32 v28, 0xffff0000, v29
  v_add_f32 v28, 0x37280000, v28
  v_cvt_pk_bf16_f32 v28, v28, v28
  v_lshlrev_b32 v28, 16, v28
  v_sqrt_f32 v28, v28
  v_lshlrev_b32 v24, 16, v24
  v_lshlrev_b32 v25, 16, v25
  v_cvt_pk_bf16_f32 v28, v28, v28
  v_lshlrev_b32 v28, 16, v28
  v_rcp_f32 v28, v28
  v_sub_f32 v24, v24, v27
  v_sub_f32 v25, v25, v27
  v_cvt_pk_bf16_f32 v29, v24, v25
  v_lshlrev_b32 v24, 16, v29
  v_and_b32 v25, 0xffff0000, v29
  v_mul_f32 v24, v24, v28
  v_mul_f32 v25, v25, v28
  v_cvt_pk_bf16_f32 v24, v24, v24
  v_cvt_pk_bf16_f32 v25, v25, v25
  s_nop 0
  v_mov_b32_dpp v58, v24 row_newbcast:0 row_mask:0xf bank_mask:0x3
  v_mov_b32_dpp v58, v25 row_newbcast:0 row_mask:0xf bank_mask:0xc
  v_and_b32 v12, v58, v4
  v_and_b32 v13, v58, v5
  v_and_b32 v14, v58, v6
  v_and_b32 v15, v58, v7
  v_mov_b32_dpp v59, v24 row_newbcast:1 row_mask:0xf bank_mask:0x3
  v_mov_b32_dpp v59, v25 row_newbcast:1 row_mask:0xf bank_mask:0xc
  v_and_b32 v16, v59, v4
  v_and_b32 v17, v59, v5
  v_and_b32 v18, v59, v6
  v_and_b32 v19, v59, v7
  v_mfma_f32_16x16x32_bf16 v[20:23], v[12:15], v[192:195], 0
  v_mov_b32_dpp v58, v24 row_newbcast:2 row_mask:0xf bank_mask:0x3
  v_mov_b32_dpp v58, v25 row_newbcast:2 row_mask:0xf bank_mask:0xc
  v_and_b32 v12, v58, v4
  v_and_b32 v13, v58, v5
  v_and_b32 v14, v58, v6
  v_and_b32 v15, v58, v7
  v_mfma_f32_16x16x32_bf16 v[20:23], v[16:19], v[196:199], v[20:23]
  v_mov_b32_dpp v59, v24 row_newbcast:3 row_mask:0xf bank_mask:0x3
  v_mov_b32_dpp v59, v25 row_newbcast:3 row_mask:0xf bank_mask:0xc
  v_and_b32 v16, v59, v4
  v_and_b32 v17, v59, v5
  v_and_b32 v18, v59, v6
  v_and_b32 v19, v59, v7
  v_mfma_f32_16x16x32_bf16 v[20:23], v[12:15], v[200:203], v[20:23]
  v_mov_b32_dpp v58, v24 row_newbcast:4 row_mask:0xf bank_mask:0x3
  v_mov_b32_dpp v58, v25 row_newbcast:4 row_mask:0xf bank_mask:0xc
  v_and_b32 v12, v58, v4
  v_and_b32 v13, v58, v5
  v_and_b32 v14, v58, v6
  v_and_b32 v15, v58, v7
  v_mfma_f32_16x16x32_bf16 v[20:23], v[16:19], v[204:207], v[20:23]
  v_mov_b32_dpp v59, v24 row_newbcast:5 row_mask:0xf bank_mask:0x3
  v_mov_b32_dpp v59, v25 row_newbcast:5 row_mask:0xf bank_mask:0xc
  v_and_b32 v16, v59, v4
  v_and_b32 v17, v59, v5
  v_and_b32 v18, v59, v6
  v_and_b32 v19, v59, v7
  v_mfma_f32_16x16x32_bf16 v[20:23], v[12:15], v[208:211], v[20:23]
  v_mov_b32_dpp v58, v24 row_newbcast:6 row_mask:0xf bank_mask:0x3
  v_mov_b32_dpp v58, v25 row_newbcast:6 row_mask:0xf bank_mask:0xc
  v_and_b32 v12, v58, v4
  v_and_b32 v13, v58, v5
  v_and_b32 v14, v58, v6
  v_and_b32 v15, v58, v7
  v_mfma_f32_16x16x32_bf16 v[20:23], v[16:19], v[212:215], v[20:23]
  v_mov_b32_dpp v59, v24 row_newbcast:7 row_mask:0xf bank_mask:0x3
  v_mov_b32_dpp v59, v25 row_newbcast:7 row_mask:0xf bank_mask:0xc
  v_and_b32 v16, v59, v4
  v_and_b32 v17, v59, v5
  v_and_b32 v18, v59, v6
  v_and_b32 v19, v59, v7
  v_mfma_f32_16x16x32_bf16 v[20:23], v[12:15], v[216:219], v[20:23]
  v_mov_b32_dpp v58, v24 row_newbcast:8 row_mask:0xf bank_mask:0x3
  v_mov_b32_dpp v58, v25 row_newbcast:8 row_mask:0xf bank_mask:0xc
  v_and_b32 v12, v58, v4
  v_and_b32 v13, v58, v5
  v_and_b32 v14, v58, v6
  v_and_b32 v15, v58, v7
  v_mfma_f32_16x16x32_bf16 v[20:23], v[16:19], v[220:223], v[20:23]
  v_mov_b32_dpp v59, v24 row_newbcast:9 row_mask:0xf bank_mask:0x3
  v_mov_b32_dpp v59, v25 row_newbcast:9 row_mask:0xf bank_mask:0xc
  v_and_b32 v16, v59, v4
  v_and_b32 v17, v59, v5
  v_and_b32 v18, v59, v6
  v_and_b32 v19, v59, v7
  v_mfma_f32_16x16x32_bf16 v[20:23], v[12:15], v[224:227], v[20:23]
  v_mov_b32_dpp v58, v24 row_newbcast:10 row_mask:0xf bank_mask:0x3
  v_mov_b32_dpp v58, v25 row_newbcast:10 row_mask:0xf bank_mask:0xc
  v_and_b32 v12, v58, v4
  v_and_b32 v13, v58, v5
  v_and_b32 v14, v58, v6
  v_and_b32 v15, v58, v7
  v_mfma_f32_16x16x32_bf16 v[20:23], v[16:19], v[228:231], v[20:23]
  v_mov_b32_dpp v59, v24 row_newbcast:11 row_mask:0xf bank_mask:0x3
  v_mov_b32_dpp v59, v25 row_newbcast:11 row_mask:0xf bank_mask:0xc
  v_and_b32 v16, v59, v4
  v_and_b32 v17, v59, v5
  v_and_b32 v18, v59, v6
  v_and_b32 v19, v59, v7
  v_mfma_f32_16x16x32_bf16 v[20:23], v[12:15], v[232:235], v[20:23]
  v_mov_b32_dpp v58, v24 row_newbcast:12 row_mask:0xf bank_mask:0x3
  v_mov_b32_dpp v58, v25 row_newbcast:12 row_mask:0xf bank_mask:0xc
  v_and_b32 v12, v58, v4
  v_and_b32 v13, v58, v5
  v_and_b32 v14, v58, v6
  v_and_b32 v15, v58, v7
  v_mfma_f32_16x16x32_bf16 v[20:23], v[16:19], v[236:239], v[20:23]
  v_mov_b32_dpp v59, v24 row_newbcast:13 row_mask:0xf bank_mask:0x3
  v_mov_b32_dpp v59, v25 row_newbcast:13 row_mask:0xf bank_mask:0xc
  v_and_b32 v16, v59, v4
  v_and_b32 v17, v59, v5
  v_and_b32 v18, v59, v6
  v_and_b32 v19, v59, v7
  v_mfma_f32_16x16x32_bf16 v[20:23], v[12:15], v[240:243], v[20:23]
  v_mov_b32_dpp v58, v24 row_newbcast:14 row_mask:0xf bank_mask:0x3
  v_mov_b32_dpp v58, v25 row_newbcast:14 row_mask:0xf bank_mask:0xc
  v_and_b32 v12, v58, v4
  v_and_b32 v13, v58, v5
  v_and_b32 v14, v58, v6
  v_and_b32 v15, v58, v7
  v_mfma_f32_16x16x32_bf16 v[20:23], v[16:19], v[244:247], v[20:23]
  v_mov_b32_dpp v59, v24 row_newbcast:15 row_mask:0xf bank_mask:0x3
  v_mov_b32_dpp v59, v25 row_newbcast:15 row_mask:0xf bank_mask:0xc
  v_and_b32 v16, v59, v4
  v_and_b32 v17, v59, v5
  v_and_b32 v18, v59, v6
  v_and_b32 v19, v59, v7
  v_mfma_f32_16x16x32_bf16 v[20:23], v[12:15], v[248:251], v[20:23]
  s_nop 0
  v_mfma_f32_16x16x32_bf16 v[20:23], v[16:19], v[252:255], v[20:23]
  s_mov_b32 exec_lo, 0x00ff00ff
  s_mov_b32 exec_hi, 0xff00ff00
  s_nop 5
  ds_write_b128 v32, v[20:23] offset:6144
  s_mov_b64 exec, -1
  v_add_u32 v32, 2048, v32
  s_add_u32 s90, s90, 1024
  s_cmp_lt_u32 s90, 8192
  s_cbranch_scc1 L_ffn1
  v_mov_b32 v27, 1
  s_waitcnt lgkmcnt(0)
  s_mov_b64 exec, 1
  ds_add_u32 v60, v27 offset:5184
  s_mov_b64 exec, -1
  s_mov_b32 s88, 0
  buffer_load_dwordx4 v[192:195], v61, s[56:59], s88 offen nt
  s_mov_b32 s88, 1024
  buffer_load_dwordx4 v[196:199], v61, s[56:59], s88 offen nt
  s_waitcnt vmcnt(1)
  s_mov_b32 s88, 2048
  buffer_load_dwordx4 v[200:203], v61, s[56:59], s88 offen nt
  s_waitcnt vmcnt(1)
  s_mov_b32 s88, 3072
  buffer_load_dwordx4 v[204:207], v61, s[56:59], s88 offen nt
  s_waitcnt vmcnt(1)
  s_mov_b32 s88, 4096
  buffer_load_dwordx4 v[208:211], v61, s[56:59], s88 offen nt
  s_waitcnt vmcnt(1)
  s_mov_b32 s88, 5120
  buffer_load_dwordx4 v[212:215], v61, s[56:59], s88 offen nt
  s_waitcnt vmcnt(1)
  s_mov_b32 s88, 6144
  buffer_load_dwordx4 v[216:219], v61, s[56:59], s88 offen nt
  s_waitcnt vmcnt(1)
  s_mov_b32 s88, 7168
  buffer_load_dwordx4 v[220:223], v61, s[56:59], s88 offen nt
  s_waitcnt vmcnt(1)
  s_mov_b32 s88, 8192
  buffer_load_dwordx4 v[224:227], v61, s[56:59], s88 offen nt
  s_waitcnt vmcnt(1)
  s_mov_b32 s88, 9216
  buffer_load_dwordx4 v[228:231], v61, s[56:59], s88 offen nt
  s_waitcnt vmcnt(1)
  s_mov_b32 s88, 10240
  buffer_load_dwordx4 v[232:235], v61, s[56:59], s88 offen nt
  s_waitcnt vmcnt(1)
  s_mov_b32 s88, 11264
  buffer_load_dwordx4 v[236:239], v61, s[56:59], s88 offen nt
  s_waitcnt vmcnt(1)
  s_mov_b32 s88, 12288
  buffer_load_dwordx4 v[240:243], v61, s[56:59], s88 offen nt
  s_waitcnt vmcnt(1)
  s_mov_b32 s88, 13312
  buffer_load_dwordx4 v[244:247], v61, s[56:59], s88 offen nt
  s_waitcnt vmcnt(1)
  s_mov_b32 s88, 14336
  buffer_load_dwordx4 v[248:251], v61, s[56:59], s88 offen nt
  s_waitcnt vmcnt(1)
  s_mov_b32 s88, 15360
  buffer_load_dwordx4 v[252:255], v61, s[56:59], s88 offen nt
L_hb:
  s_sleep 1
  ds_read_b32 v27, v60 offset:5184
  s_waitcnt lgkmcnt(0)
  v_readfirstlane_b32 s88, v27
  s_nop 0
  s_cmp_lt_u32 s88, 4
  s_cbranch_scc1 L_hb
  v_lshlrev_b32 v32, 2, v1
  v_lshlrev_b32 v56, 16, v56
  v_lshrrev_b32 v57, 5, v1
  v_lshl_add_u32 v57, v57, 11, v35
  s_lshl_b32 s90, s5, 14
  s_add_u32 s90, s90, 65536
  s_add_u32 s91, s90, 16384
  s_waitcnt vmcnt(0)
L_ffn2:
  ds_read2st64_b32 v[40:41], v32 offset0:24 offset1:25
  ds_read2st64_b32 v[42:43], v32 offset0:26 offset1:27
  ds_read2st64_b32 v[44:45], v32 offset0:28 offset1:29
  ds_read2st64_b32 v[46:47], v32 offset0:30 offset1:31
  s_waitcnt lgkmcnt(0)
  v_add_f32 v40, v40, v41
  v_add_f32 v42, v42, v43
  v_add_f32 v44, v44, v45
  v_add_f32 v46, v46, v47
  v_add_f32 v40, v40, v42
  v_add_f32 v44, v44, v46
  v_add_f32 v26, v40, v44
  v_cvt_pk_bf16_f32 v26, v26, v26
  v_lshlrev_b32 v26, 16, v26
  v_add_f32 v26, v26, v56
  v_cvt_pk_bf16_f32 v26, v26, v26
  v_lshlrev_b32 v26, 16, v26
  v_mul_f32 v27, v26, v26
  v_mul_f32 v27, v27, v26
  v_mov_b32 v28, 0x3d372713
  v_fma_f32 v27, v27, v28, v26
  v_mul_f32 v27, 0xc0135761, v27
  v_exp_f32 v27, v27
  s_nop 0
  v_add_f32 v27, 1.0, v27
  v_rcp_f32 v27, v27
  s_nop 0
  v_mul_f32 v26, v26, v27
  v_cvt_pk_bf16_f32 v24, v26, v26
  ds_read2st64_b32 v[40:41], v32 offset0:32 offset1:33
  ds_read2st64_b32 v[42:43], v32 offset0:34 offset1:35
  ds_read2st64_b32 v[44:45], v32 offset0:36 offset1:37
  ds_read2st64_b32 v[46:47], v32 offset0:38 offset1:39
  s_waitcnt lgkmcnt(0)
  v_add_f32 v40, v40, v41
  v_add_f32 v42, v42, v43
  v_add_f32 v44, v44, v45
  v_add_f32 v46, v46, v47
  v_add_f32 v40, v40, v42
  v_add_f32 v44, v44, v46
  v_add_f32 v26, v40, v44
  v_cvt_pk_bf16_f32 v26, v26, v26
  v_lshlrev_b32 v26, 16, v26
  v_add_f32 v26, v26, v56
  v_cvt_pk_bf16_f32 v26, v26, v26
  v_lshlrev_b32 v26, 16, v26
  v_mul_f32 v27, v26, v26
  v_mul_f32 v27, v27, v26
  v_mov_b32 v28, 0x3d372713
  v_fma_f32 v27, v27, v28, v26
  v_mul_f32 v27, 0xc0135761, v27
  v_exp_f32 v27, v27
  s_nop 0
  v_add_f32 v27, 1.0, v27
  v_rcp_f32 v27, v27
  s_nop 0
  v_mul_f32 v26, v26, v27
  v_cvt_pk_bf16_f32 v25, v26, v26
  v_mov_b32_dpp v58, v24 row_newbcast:0 row_mask:0xf bank_mask:0x3
  s_nop 0
  v_mov_b32_dpp v58, v25 row_newbcast:0 row_mask:0xf bank_mask:0xc
  v_and_b32 v12, v58, v4
  v_and_b32 v13, v58, v5
  v_and_b32 v14, v58, v6
  v_and_b32 v15, v58, v7
  v_mov_b32_dpp v59, v24 row_newbcast:1 row_mask:0xf bank_mask:0x3
  v_mov_b32_dpp v59, v25 row_newbcast:1 row_mask:0xf bank_mask:0xc
  v_and_b32 v16, v59, v4
  v_and_b32 v17, v59, v5
  v_and_b32 v18, v59, v6
  v_and_b32 v19, v59, v7
  v_mfma_f32_16x16x32_bf16 v[20:23], v[12:15], v[192:195], 0
  v_mov_b32_dpp v58, v24 row_newbcast:2 row_mask:0xf bank_mask:0x3
  v_mov_b32_dpp v58, v25 row_newbcast:2 row_mask:0xf bank_mask:0xc
  v_and_b32 v12, v58, v4
  v_and_b32 v13, v58, v5
  v_and_b32 v14, v58, v6
  v_and_b32 v15, v58, v7
  v_mfma_f32_16x16x32_bf16 v[20:23], v[16:19], v[196:199], v[20:23]
  v_mov_b32_dpp v59, v24 row_newbcast:3 row_mask:0xf bank_mask:0x3
  v_mov_b32_dpp v59, v25 row_newbcast:3 row_mask:0xf bank_mask:0xc
  v_and_b32 v16, v59, v4
  v_and_b32 v17, v59, v5
  v_and_b32 v18, v59, v6
  v_and_b32 v19, v59, v7
  v_mfma_f32_16x16x32_bf16 v[20:23], v[12:15], v[200:203], v[20:23]
  v_mov_b32_dpp v58, v24 row_newbcast:4 row_mask:0xf bank_mask:0x3
  v_mov_b32_dpp v58, v25 row_newbcast:4 row_mask:0xf bank_mask:0xc
  v_and_b32 v12, v58, v4
  v_and_b32 v13, v58, v5
  v_and_b32 v14, v58, v6
  v_and_b32 v15, v58, v7
  v_mfma_f32_16x16x32_bf16 v[20:23], v[16:19], v[204:207], v[20:23]
  v_mov_b32_dpp v59, v24 row_newbcast:5 row_mask:0xf bank_mask:0x3
  v_mov_b32_dpp v59, v25 row_newbcast:5 row_mask:0xf bank_mask:0xc
  v_and_b32 v16, v59, v4
  v_and_b32 v17, v59, v5
  v_and_b32 v18, v59, v6
  v_and_b32 v19, v59, v7
  v_mfma_f32_16x16x32_bf16 v[20:23], v[12:15], v[208:211], v[20:23]
  v_mov_b32_dpp v58, v24 row_newbcast:6 row_mask:0xf bank_mask:0x3
  v_mov_b32_dpp v58, v25 row_newbcast:6 row_mask:0xf bank_mask:0xc
  v_and_b32 v12, v58, v4
  v_and_b32 v13, v58, v5
  v_and_b32 v14, v58, v6
  v_and_b32 v15, v58, v7
  v_mfma_f32_16x16x32_bf16 v[20:23], v[16:19], v[212:215], v[20:23]
  v_mov_b32_dpp v59, v24 row_newbcast:7 row_mask:0xf bank_mask:0x3
  v_mov_b32_dpp v59, v25 row_newbcast:7 row_mask:0xf bank_mask:0xc
  v_and_b32 v16, v59, v4
  v_and_b32 v17, v59, v5
  v_and_b32 v18, v59, v6
  v_and_b32 v19, v59, v7
  v_mfma_f32_16x16x32_bf16 v[20:23], v[12:15], v[216:219], v[20:23]
  v_mov_b32_dpp v58, v24 row_newbcast:8 row_mask:0xf bank_mask:0x3
  v_mov_b32_dpp v58, v25 row_newbcast:8 row_mask:0xf bank_mask:0xc
  v_and_b32 v12, v58, v4
  v_and_b32 v13, v58, v5
  v_and_b32 v14, v58, v6
  v_and_b32 v15, v58, v7
  v_mfma_f32_16x16x32_bf16 v[20:23], v[16:19], v[220:223], v[20:23]
  v_mov_b32_dpp v59, v24 row_newbcast:9 row_mask:0xf bank_mask:0x3
  v_mov_b32_dpp v59, v25 row_newbcast:9 row_mask:0xf bank_mask:0xc
  v_and_b32 v16, v59, v4
  v_and_b32 v17, v59, v5
  v_and_b32 v18, v59, v6
  v_and_b32 v19, v59, v7
  v_mfma_f32_16x16x32_bf16 v[20:23], v[12:15], v[224:227], v[20:23]
  v_mov_b32_dpp v58, v24 row_newbcast:10 row_mask:0xf bank_mask:0x3
  v_mov_b32_dpp v58, v25 row_newbcast:10 row_mask:0xf bank_mask:0xc
  v_and_b32 v12, v58, v4
  v_and_b32 v13, v58, v5
  v_and_b32 v14, v58, v6
  v_and_b32 v15, v58, v7
  v_mfma_f32_16x16x32_bf16 v[20:23], v[16:19], v[228:231], v[20:23]
  v_mov_b32_dpp v59, v24 row_newbcast:11 row_mask:0xf bank_mask:0x3
  v_mov_b32_dpp v59, v25 row_newbcast:11 row_mask:0xf bank_mask:0xc
  v_and_b32 v16, v59, v4
  v_and_b32 v17, v59, v5
  v_and_b32 v18, v59, v6
  v_and_b32 v19, v59, v7
  v_mfma_f32_16x16x32_bf16 v[20:23], v[12:15], v[232:235], v[20:23]
  v_mov_b32_dpp v58, v24 row_newbcast:12 row_mask:0xf bank_mask:0x3
  v_mov_b32_dpp v58, v25 row_newbcast:12 row_mask:0xf bank_mask:0xc
  v_and_b32 v12, v58, v4
  v_and_b32 v13, v58, v5
  v_and_b32 v14, v58, v6
  v_and_b32 v15, v58, v7
  v_mfma_f32_16x16x32_bf16 v[20:23], v[16:19], v[236:239], v[20:23]
  v_mov_b32_dpp v59, v24 row_newbcast:13 row_mask:0xf bank_mask:0x3
  v_mov_b32_dpp v59, v25 row_newbcast:13 row_mask:0xf bank_mask:0xc
  v_and_b32 v16, v59, v4
  v_and_b32 v17, v59, v5
  v_and_b32 v18, v59, v6
  v_and_b32 v19, v59, v7
  v_mfma_f32_16x16x32_bf16 v[20:23], v[12:15], v[240:243], v[20:23]
  v_mov_b32_dpp v58, v24 row_newbcast:14 row_mask:0xf bank_mask:0x3
  v_mov_b32_dpp v58, v25 row_newbcast:14 row_mask:0xf bank_mask:0xc
  v_and_b32 v12, v58, v4
  v_and_b32 v13, v58, v5
  v_and_b32 v14, v58, v6
  v_and_b32 v15, v58, v7
  v_mfma_f32_16x16x32_bf16 v[20:23], v[16:19], v[244:247], v[20:23]
  v_mov_b32_dpp v59, v24 row_newbcast:15 row_mask:0xf bank_mask:0x3
  v_mov_b32_dpp v59, v25 row_newbcast:15 row_mask:0xf bank_mask:0xc
  v_and_b32 v16, v59, v4
  v_and_b32 v17, v59, v5
  v_and_b32 v18, v59, v6
  v_and_b32 v19, v59, v7
  v_mfma_f32_16x16x32_bf16 v[20:23], v[12:15], v[248:251], v[20:23]
  s_nop 0
  v_mfma_f32_16x16x32_bf16 v[20:23], v[16:19], v[252:255], v[20:23]
  s_nop 7
  buffer_store_dwordx4 v[20:23], v57, s[72:75], s90 offen sc1
  v_add_u32 v32, 4096, v32
  s_add_u32 s90, s90, 4096
  s_cmp_lt_u32 s90, s91
  s_cbranch_scc1 L_ffn2
  s_lshl_b32 s88, s6, 7
  s_add_u32 s88, s88, 20480
  v_mov_b32 v27, 1
  s_waitcnt vmcnt(0)
  s_mov_b64 exec, 1
  buffer_atomic_add v27, v60, s[72:75], s88 offen
  s_mov_b64 exec, -1
L_noffn:
  s_lshl_b32 s91, s4, 11
  s_lshl_b32 s85, s4, 2
  s_add_u32 s85, s85, s6
  s_lshl_b32 s85, s85, 7
  s_add_u32 s85, s85, 16384
  s_add_u32 s86, s91, 32768
  s_cmp_lg_u32 s5, 31
  s_cbranch_scc1 L_nof
  s_lshl_b32 s7, s6, 7
  s_add_u32 s7, s7, 20480
  v_lshrrev_b32 v45, 5, v1
  v_lshl_add_u32 v45, v45, 14, v35
  v_add_u32 v45, s91, v45
L_pollf:
  s_sleep 16
  ds_read_b32 v28, v60 offset:5188
  s_waitcnt lgkmcnt(0)
  v_readfirstlane_b32 s89, v28
  s_nop 0
  s_cmp_eq_u32 s89, 0
  s_cbranch_scc1 L_pollf
  s_mov_b32 s87, 0
L_pollf2:
  buffer_load_dword v27, v60, s[72:75], s7 offen sc1
  s_waitcnt vmcnt(0)
  v_readfirstlane_b32 s88, v27
  s_nop 0
  s_cmp_ge_u32 s88, 28
  s_cbranch_scc1 L_gotf
  s_sleep 32
  s_add_u32 s87, s87, 1
  s_cmp_lt_u32 s87, 0x40000
  s_cbranch_scc1 L_pollf2
L_gotf:
  s_mov_b32 s88, 65536
  buffer_load_dwordx4 v[192:195], v45, s[72:75], s88 offen sc1
  s_mov_b32 s88, 98304
  buffer_load_dwordx4 v[196:199], v45, s[72:75], s88 offen sc1
  s_waitcnt vmcnt(1)
  s_mov_b32 s88, 131072
  buffer_load_dwordx4 v[200:203], v45, s[72:75], s88 offen sc1
  s_waitcnt vmcnt(1)
  s_mov_b32 s88, 163840
  buffer_load_dwordx4 v[204:207], v45, s[72:75], s88 offen sc1
  s_waitcnt vmcnt(1)
  s_mov_b32 s88, 196608
  buffer_load_dwordx4 v[208:211], v45, s[72:75], s88 offen sc1
  s_waitcnt vmcnt(1)
  s_mov_b32 s88, 229376
  buffer_load_dwordx4 v[212:215], v45, s[72:75], s88 offen sc1
  s_waitcnt vmcnt(1)
  s_mov_b32 s88, 262144
  buffer_load_dwordx4 v[216:219], v45, s[72:75], s88 offen sc1
  s_waitcnt vmcnt(1)
  s_mov_b32 s88, 294912
  buffer_load_dwordx4 v[220:223], v45, s[72:75], s88 offen sc1
  s_waitcnt vmcnt(1)
  s_mov_b32 s88, 327680
  buffer_load_dwordx4 v[224:227], v45, s[72:75], s88 offen sc1
  s_waitcnt vmcnt(1)
  s_mov_b32 s88, 360448
  buffer_load_dwordx4 v[228:231], v45, s[72:75], s88 offen sc1
  s_waitcnt vmcnt(1)
  s_mov_b32 s88, 393216
  buffer_load_dwordx4 v[232:235], v45, s[72:75], s88 offen sc1
  s_waitcnt vmcnt(1)
  s_mov_b32 s88, 425984
  buffer_load_dwordx4 v[236:239], v45, s[72:75], s88 offen sc1
  s_waitcnt vmcnt(1)
  s_mov_b32 s88, 458752
  buffer_load_dwordx4 v[240:243], v45, s[72:75], s88 offen sc1
  s_waitcnt vmcnt(1)
  s_mov_b32 s88, 491520
  buffer_load_dwordx4 v[244:247], v45, s[72:75], s88 offen sc1
  s_waitcnt vmcnt(0)
  v_add_f32 v36, v192, v196
  v_add_f32 v37, v193, v197
  v_add_f32 v38, v194, v198
  v_add_f32 v39, v195, v199
  v_add_f32 v36, v36, v200
  v_add_f32 v37, v37, v201
  v_add_f32 v38, v38, v202
  v_add_f32 v39, v39, v203
  v_add_f32 v36, v36, v204
  v_add_f32 v37, v37, v205
  v_add_f32 v38, v38, v206
  v_add_f32 v39, v39, v207
  v_add_f32 v36, v36, v208
  v_add_f32 v37, v37, v209
  v_add_f32 v38, v38, v210
  v_add_f32 v39, v39, v211
  v_add_f32 v36, v36, v212
  v_add_f32 v37, v37, v213
  v_add_f32 v38, v38, v214
  v_add_f32 v39, v39, v215
  v_add_f32 v36, v36, v216
  v_add_f32 v37, v37, v217
  v_add_f32 v38, v38, v218
  v_add_f32 v39, v39, v219
  v_add_f32 v36, v36, v220
  v_add_f32 v37, v37, v221
  v_add_f32 v38, v38, v222
  v_add_f32 v39, v39, v223
  v_add_f32 v36, v36, v224
  v_add_f32 v37, v37, v225
  v_add_f32 v38, v38, v226
  v_add_f32 v39, v39, v227
  v_add_f32 v36, v36, v228
  v_add_f32 v37, v37, v229
  v_add_f32 v38, v38, v230
  v_add_f32 v39, v39, v231
  v_add_f32 v36, v36, v232
  v_add_f32 v37, v37, v233
  v_add_f32 v38, v38, v234
  v_add_f32 v39, v39, v235
  v_add_f32 v36, v36, v236
  v_add_f32 v37, v37, v237
  v_add_f32 v38, v38, v238
  v_add_f32 v39, v39, v239
  v_add_f32 v36, v36, v240
  v_add_f32 v37, v37, v241
  v_add_f32 v38, v38, v242
  v_add_f32 v39, v39, v243
  v_add_f32 v36, v36, v244
  v_add_f32 v37, v37, v245
  v_add_f32 v38, v38, v246
  v_add_f32 v39, v39, v247
  v_mov_b32 v40, v36
  v_mov_b32 v41, v37
  v_mov_b32 v42, v38
  v_mov_b32 v43, v39
  v_permlane32_swap_b32 v36, v40
  v_permlane32_swap_b32 v37, v41
  v_permlane32_swap_b32 v38, v42
  v_permlane32_swap_b32 v39, v43
  v_add_f32 v36, v36, v40
  v_add_f32 v37, v37, v41
  v_add_f32 v38, v38, v42
  v_add_f32 v39, v39, v43
  v_cvt_pk_bf16_f32 v40, v36, v37
  v_cvt_pk_bf16_f32 v41, v38, v39
  v_lshlrev_b32 v36, 16, v40
  v_and_b32 v37, 0xffff0000, v40
  v_lshlrev_b32 v38, 16, v41
  v_and_b32 v39, 0xffff0000, v41
  v_lshlrev_b32 v40, 16, v48
  v_and_b32 v41, 0xffff0000, v48
  v_lshlrev_b32 v42, 16, v49
  v_and_b32 v43, 0xffff0000, v49
  v_add_f32 v36, v36, v40
  v_add_f32 v37, v37, v41
  v_add_f32 v38, v38, v42
  v_add_f32 v39, v39, v43
  v_cvt_pk_bf16_f32 v40, v36, v37
  v_cvt_pk_bf16_f32 v41, v38, v39
  v_lshlrev_b32 v36, 16, v40
  v_and_b32 v37, 0xffff0000, v40
  v_lshlrev_b32 v38, 16, v41
  v_and_b32 v39, 0xffff0000, v41
  s_mov_b32 exec_hi, 0
  buffer_store_dwordx4 v[36:39], v35, s[72:75], s86 offen sc1
  s_mov_b64 exec, -1
L_nof:
  v_lshlrev_b32 v26, 2, v1
  s_waitcnt vmcnt(0)
  v_lshlrev_b32 v4, 16, v52
  v_and_b32 v5, 0xffff0000, v52
  v_lshlrev_b32 v6, 16, v53
  v_and_b32 v7, 0xffff0000, v53
  s_barrier
  ds_read2st64_b32 v[40:41], v26 offset0:12 offset1:13
  ds_read2st64_b32 v[42:43], v26 offset0:14 offset1:15
  ds_read2st64_b32 v[44:45], v26 offset0:16 offset1:17
  ds_read2st64_b32 v[46:47], v26 offset0:18 offset1:19
  s_waitcnt lgkmcnt(0)
  v_add_f32 v40, v40, v42
  v_add_f32 v41, v41, v43
  v_add_f32 v44, v44, v46
  v_add_f32 v45, v45, v47
  v_add_f32 v24, v40, v44
  v_add_f32 v25, v41, v45
  v_cvt_pk_bf16_f32 v24, v24, v24
  v_cvt_pk_bf16_f32 v25, v25, v25
  s_nop 0
  v_and_b32_dpp v12, v24, v8 row_newbcast:0 row_mask:0xf bank_mask:0xf
  v_and_b32_dpp v13, v24, v9 row_newbcast:0 row_mask:0xf bank_mask:0xf
  v_and_b32_dpp v14, v24, v10 row_newbcast:0 row_mask:0xf bank_mask:0xf
  v_and_b32_dpp v15, v24, v11 row_newbcast:0 row_mask:0xf bank_mask:0xf
  v_and_b32_dpp v16, v24, v8 row_newbcast:1 row_mask:0xf bank_mask:0xf
  v_and_b32_dpp v17, v24, v9 row_newbcast:1 row_mask:0xf bank_mask:0xf
  v_and_b32_dpp v18, v24, v10 row_newbcast:1 row_mask:0xf bank_mask:0xf
  v_and_b32_dpp v19, v24, v11 row_newbcast:1 row_mask:0xf bank_mask:0xf
  v_mfma_f32_16x16x32_bf16 v[20:23], v[12:15], v[64:67], 0
  v_and_b32_dpp v12, v24, v8 row_newbcast:2 row_mask:0xf bank_mask:0xf
  v_and_b32_dpp v13, v24, v9 row_newbcast:2 row_mask:0xf bank_mask:0xf
  v_and_b32_dpp v14, v24, v10 row_newbcast:2 row_mask:0xf bank_mask:0xf
  v_and_b32_dpp v15, v24, v11 row_newbcast:2 row_mask:0xf bank_mask:0xf
  v_mfma_f32_16x16x32_bf16 v[20:23], v[16:19], v[68:71], v[20:23]
  v_and_b32_dpp v16, v24, v8 row_newbcast:3 row_mask:0xf bank_mask:0xf
  v_and_b32_dpp v17, v24, v9 row_newbcast:3 row_mask:0xf bank_mask:0xf
  v_and_b32_dpp v18, v24, v10 row_newbcast:3 row_mask:0xf bank_mask:0xf
  v_and_b32_dpp v19, v24, v11 row_newbcast:3 row_mask:0xf bank_mask:0xf
  v_mfma_f32_16x16x32_bf16 v[20:23], v[12:15], v[72:75], v[20:23]
  v_and_b32_dpp v12, v24, v8 row_newbcast:4 row_mask:0xf bank_mask:0xf
  v_and_b32_dpp v13, v24, v9 row_newbcast:4 row_mask:0xf bank_mask:0xf
  v_and_b32_dpp v14, v24, v10 row_newbcast:4 row_mask:0xf bank_mask:0xf
  v_and_b32_dpp v15, v24, v11 row_newbcast:4 row_mask:0xf bank_mask:0xf
  v_mfma_f32_16x16x32_bf16 v[20:23], v[16:19], v[76:79], v[20:23]
  v_and_b32_dpp v16, v24, v8 row_newbcast:5 row_mask:0xf bank_mask:0xf
  v_and_b32_dpp v17, v24, v9 row_newbcast:5 row_mask:0xf bank_mask:0xf
  v_and_b32_dpp v18, v24, v10 row_newbcast:5 row_mask:0xf bank_mask:0xf
  v_and_b32_dpp v19, v24, v11 row_newbcast:5 row_mask:0xf bank_mask:0xf
  v_mfma_f32_16x16x32_bf16 v[20:23], v[12:15], v[80:83], v[20:23]
  v_and_b32_dpp v12, v24, v8 row_newbcast:6 row_mask:0xf bank_mask:0xf
  v_and_b32_dpp v13, v24, v9 row_newbcast:6 row_mask:0xf bank_mask:0xf
  v_and_b32_dpp v14, v24, v10 row_newbcast:6 row_mask:0xf bank_mask:0xf
  v_and_b32_dpp v15, v24, v11 row_newbcast:6 row_mask:0xf bank_mask:0xf
  v_mfma_f32_16x16x32_bf16 v[20:23], v[16:19], v[84:87], v[20:23]
  v_and_b32_dpp v16, v24, v8 row_newbcast:7 row_mask:0xf bank_mask:0xf
  v_and_b32_dpp v17, v24, v9 row_newbcast:7 row_mask:0xf bank_mask:0xf
  v_and_b32_dpp v18, v24, v10 row_newbcast:7 row_mask:0xf bank_mask:0xf
  v_and_b32_dpp v19, v24, v11 row_newbcast:7 row_mask:0xf bank_mask:0xf
  v_mfma_f32_16x16x32_bf16 v[20:23], v[12:15], v[88:91], v[20:23]
  v_and_b32_dpp v12, v24, v8 row_newbcast:8 row_mask:0xf bank_mask:0xf
  v_and_b32_dpp v13, v24, v9 row_newbcast:8 row_mask:0xf bank_mask:0xf
  v_and_b32_dpp v14, v24, v10 row_newbcast:8 row_mask:0xf bank_mask:0xf
  v_and_b32_dpp v15, v24, v11 row_newbcast:8 row_mask:0xf bank_mask:0xf
  v_mfma_f32_16x16x32_bf16 v[20:23], v[16:19], v[92:95], v[20:23]
  v_and_b32_dpp v16, v24, v8 row_newbcast:9 row_mask:0xf bank_mask:0xf
  v_and_b32_dpp v17, v24, v9 row_newbcast:9 row_mask:0xf bank_mask:0xf
  v_and_b32_dpp v18, v24, v10 row_newbcast:9 row_mask:0xf bank_mask:0xf
  v_and_b32_dpp v19, v24, v11 row_newbcast:9 row_mask:0xf bank_mask:0xf
  v_mfma_f32_16x16x32_bf16 v[20:23], v[12:15], v[96:99], v[20:23]
  v_and_b32_dpp v12, v24, v8 row_newbcast:10 row_mask:0xf bank_mask:0xf
  v_and_b32_dpp v13, v24, v9 row_newbcast:10 row_mask:0xf bank_mask:0xf
  v_and_b32_dpp v14, v24, v10 row_newbcast:10 row_mask:0xf bank_mask:0xf
  v_and_b32_dpp v15, v24, v11 row_newbcast:10 row_mask:0xf bank_mask:0xf
  v_mfma_f32_16x16x32_bf16 v[20:23], v[16:19], v[100:103], v[20:23]
  v_and_b32_dpp v16, v24, v8 row_newbcast:11 row_mask:0xf bank_mask:0xf
  v_and_b32_dpp v17, v24, v9 row_newbcast:11 row_mask:0xf bank_mask:0xf
  v_and_b32_dpp v18, v24, v10 row_newbcast:11 row_mask:0xf bank_mask:0xf
  v_and_b32_dpp v19, v24, v11 row_newbcast:11 row_mask:0xf bank_mask:0xf
  v_mfma_f32_16x16x32_bf16 v[20:23], v[12:15], v[104:107], v[20:23]
  v_and_b32_dpp v12, v24, v8 row_newbcast:12 row_mask:0xf bank_mask:0xf
  v_and_b32_dpp v13, v24, v9 row_newbcast:12 row_mask:0xf bank_mask:0xf
  v_and_b32_dpp v14, v24, v10 row_newbcast:12 row_mask:0xf bank_mask:0xf
  v_and_b32_dpp v15, v24, v11 row_newbcast:12 row_mask:0xf bank_mask:0xf
  v_mfma_f32_16x16x32_bf16 v[20:23], v[16:19], v[108:111], v[20:23]
  v_and_b32_dpp v16, v24, v8 row_newbcast:13 row_mask:0xf bank_mask:0xf
  v_and_b32_dpp v17, v24, v9 row_newbcast:13 row_mask:0xf bank_mask:0xf
  v_and_b32_dpp v18, v24, v10 row_newbcast:13 row_mask:0xf bank_mask:0xf
  v_and_b32_dpp v19, v24, v11 row_newbcast:13 row_mask:0xf bank_mask:0xf
  v_mfma_f32_16x16x32_bf16 v[20:23], v[12:15], v[112:115], v[20:23]
  v_and_b32_dpp v12, v24, v8 row_newbcast:14 row_mask:0xf bank_mask:0xf
  v_and_b32_dpp v13, v24, v9 row_newbcast:14 row_mask:0xf bank_mask:0xf
  v_and_b32_dpp v14, v24, v10 row_newbcast:14 row_mask:0xf bank_mask:0xf
  v_and_b32_dpp v15, v24, v11 row_newbcast:14 row_mask:0xf bank_mask:0xf
  v_mfma_f32_16x16x32_bf16 v[20:23], v[16:19], v[116:119], v[20:23]
  v_and_b32_dpp v16, v24, v8 row_newbcast:15 row_mask:0xf bank_mask:0xf
  v_and_b32_dpp v17, v24, v9 row_newbcast:15 row_mask:0xf bank_mask:0xf
  v_and_b32_dpp v18, v24, v10 row_newbcast:15 row_mask:0xf bank_mask:0xf
  v_and_b32_dpp v19, v24, v11 row_newbcast:15 row_mask:0xf bank_mask:0xf
  v_mfma_f32_16x16x32_bf16 v[20:23], v[12:15], v[120:123], v[20:23]
  v_and_b32_dpp v12, v25, v8 row_newbcast:0 row_mask:0xf bank_mask:0xf
  v_and_b32_dpp v13, v25, v9 row_newbcast:0 row_mask:0xf bank_mask:0xf
  v_and_b32_dpp v14, v25, v10 row_newbcast:0 row_mask:0xf bank_mask:0xf
  v_and_b32_dpp v15, v25, v11 row_newbcast:0 row_mask:0xf bank_mask:0xf
  v_mfma_f32_16x16x32_bf16 v[20:23], v[16:19], v[124:127], v[20:23]
  v_and_b32_dpp v16, v25, v8 row_newbcast:1 row_mask:0xf bank_mask:0xf
  v_and_b32_dpp v17, v25, v9 row_newbcast:1 row_mask:0xf bank_mask:0xf
  v_and_b32_dpp v18, v25, v10 row_newbcast:1 row_mask:0xf bank_mask:0xf
  v_and_b32_dpp v19, v25, v11 row_newbcast:1 row_mask:0xf bank_mask:0xf
  v_mfma_f32_16x16x32_bf16 v[20:23], v[12:15], v[128:131], v[20:23]
  v_and_b32_dpp v12, v25, v8 row_newbcast:2 row_mask:0xf bank_mask:0xf
  v_and_b32_dpp v13, v25, v9 row_newbcast:2 row_mask:0xf bank_mask:0xf
  v_and_b32_dpp v14, v25, v10 row_newbcast:2 row_mask:0xf bank_mask:0xf
  v_and_b32_dpp v15, v25, v11 row_newbcast:2 row_mask:0xf bank_mask:0xf
  v_mfma_f32_16x16x32_bf16 v[20:23], v[16:19], v[132:135], v[20:23]
  v_and_b32_dpp v16, v25, v8 row_newbcast:3 row_mask:0xf bank_mask:0xf
  v_and_b32_dpp v17, v25, v9 row_newbcast:3 row_mask:0xf bank_mask:0xf
  v_and_b32_dpp v18, v25, v10 row_newbcast:3 row_mask:0xf bank_mask:0xf
  v_and_b32_dpp v19, v25, v11 row_newbcast:3 row_mask:0xf bank_mask:0xf
  v_mfma_f32_16x16x32_bf16 v[20:23], v[12:15], v[136:139], v[20:23]
  v_and_b32_dpp v12, v25, v8 row_newbcast:4 row_mask:0xf bank_mask:0xf
  v_and_b32_dpp v13, v25, v9 row_newbcast:4 row_mask:0xf bank_mask:0xf
  v_and_b32_dpp v14, v25, v10 row_newbcast:4 row_mask:0xf bank_mask:0xf
  v_and_b32_dpp v15, v25, v11 row_newbcast:4 row_mask:0xf bank_mask:0xf
  v_mfma_f32_16x16x32_bf16 v[20:23], v[16:19], v[140:143], v[20:23]
  v_and_b32_dpp v16, v25, v8 row_newbcast:5 row_mask:0xf bank_mask:0xf
  v_and_b32_dpp v17, v25, v9 row_newbcast:5 row_mask:0xf bank_mask:0xf
  v_and_b32_dpp v18, v25, v10 row_newbcast:5 row_mask:0xf bank_mask:0xf
  v_and_b32_dpp v19, v25, v11 row_newbcast:5 row_mask:0xf bank_mask:0xf
  v_mfma_f32_16x16x32_bf16 v[20:23], v[12:15], v[144:147], v[20:23]
  v_and_b32_dpp v12, v25, v8 row_newbcast:6 row_mask:0xf bank_mask:0xf
  v_and_b32_dpp v13, v25, v9 row_newbcast:6 row_mask:0xf bank_mask:0xf
  v_and_b32_dpp v14, v25, v10 row_newbcast:6 row_mask:0xf bank_mask:0xf
  v_and_b32_dpp v15, v25, v11 row_newbcast:6 row_mask:0xf bank_mask:0xf
  v_mfma_f32_16x16x32_bf16 v[20:23], v[16:19], v[148:151], v[20:23]
  v_and_b32_dpp v16, v25, v8 row_newbcast:7 row_mask:0xf bank_mask:0xf
  v_and_b32_dpp v17, v25, v9 row_newbcast:7 row_mask:0xf bank_mask:0xf
  v_and_b32_dpp v18, v25, v10 row_newbcast:7 row_mask:0xf bank_mask:0xf
  v_and_b32_dpp v19, v25, v11 row_newbcast:7 row_mask:0xf bank_mask:0xf
  v_mfma_f32_16x16x32_bf16 v[20:23], v[12:15], v[152:155], v[20:23]
  v_and_b32_dpp v12, v25, v8 row_newbcast:8 row_mask:0xf bank_mask:0xf
  v_and_b32_dpp v13, v25, v9 row_newbcast:8 row_mask:0xf bank_mask:0xf
  v_and_b32_dpp v14, v25, v10 row_newbcast:8 row_mask:0xf bank_mask:0xf
  v_and_b32_dpp v15, v25, v11 row_newbcast:8 row_mask:0xf bank_mask:0xf
  v_mfma_f32_16x16x32_bf16 v[20:23], v[16:19], v[156:159], v[20:23]
  v_and_b32_dpp v16, v25, v8 row_newbcast:9 row_mask:0xf bank_mask:0xf
  v_and_b32_dpp v17, v25, v9 row_newbcast:9 row_mask:0xf bank_mask:0xf
  v_and_b32_dpp v18, v25, v10 row_newbcast:9 row_mask:0xf bank_mask:0xf
  v_and_b32_dpp v19, v25, v11 row_newbcast:9 row_mask:0xf bank_mask:0xf
  v_mfma_f32_16x16x32_bf16 v[20:23], v[12:15], v[160:163], v[20:23]
  v_and_b32_dpp v12, v25, v8 row_newbcast:10 row_mask:0xf bank_mask:0xf
  v_and_b32_dpp v13, v25, v9 row_newbcast:10 row_mask:0xf bank_mask:0xf
  v_and_b32_dpp v14, v25, v10 row_newbcast:10 row_mask:0xf bank_mask:0xf
  v_and_b32_dpp v15, v25, v11 row_newbcast:10 row_mask:0xf bank_mask:0xf
  v_mfma_f32_16x16x32_bf16 v[20:23], v[16:19], v[164:167], v[20:23]
  v_and_b32_dpp v16, v25, v8 row_newbcast:11 row_mask:0xf bank_mask:0xf
  v_and_b32_dpp v17, v25, v9 row_newbcast:11 row_mask:0xf bank_mask:0xf
  v_and_b32_dpp v18, v25, v10 row_newbcast:11 row_mask:0xf bank_mask:0xf
  v_and_b32_dpp v19, v25, v11 row_newbcast:11 row_mask:0xf bank_mask:0xf
  v_mfma_f32_16x16x32_bf16 v[20:23], v[12:15], v[168:171], v[20:23]
  v_and_b32_dpp v12, v25, v8 row_newbcast:12 row_mask:0xf bank_mask:0xf
  v_and_b32_dpp v13, v25, v9 row_newbcast:12 row_mask:0xf bank_mask:0xf
  v_and_b32_dpp v14, v25, v10 row_newbcast:12 row_mask:0xf bank_mask:0xf
  v_and_b32_dpp v15, v25, v11 row_newbcast:12 row_mask:0xf bank_mask:0xf
  v_mfma_f32_16x16x32_bf16 v[20:23], v[16:19], v[172:175], v[20:23]
  v_and_b32_dpp v16, v25, v8 row_newbcast:13 row_mask:0xf bank_mask:0xf
  v_and_b32_dpp v17, v25, v9 row_newbcast:13 row_mask:0xf bank_mask:0xf
  v_and_b32_dpp v18, v25, v10 row_newbcast:13 row_mask:0xf bank_mask:0xf
  v_and_b32_dpp v19, v25, v11 row_newbcast:13 row_mask:0xf bank_mask:0xf
  v_mfma_f32_16x16x32_bf16 v[20:23], v[12:15], v[176:179], v[20:23]
  v_and_b32_dpp v12, v25, v8 row_newbcast:14 row_mask:0xf bank_mask:0xf
  v_and_b32_dpp v13, v25, v9 row_newbcast:14 row_mask:0xf bank_mask:0xf
  v_and_b32_dpp v14, v25, v10 row_newbcast:14 row_mask:0xf bank_mask:0xf
  v_and_b32_dpp v15, v25, v11 row_newbcast:14 row_mask:0xf bank_mask:0xf
  v_mfma_f32_16x16x32_bf16 v[20:23], v[16:19], v[180:183], v[20:23]
  v_and_b32_dpp v16, v25, v8 row_newbcast:15 row_mask:0xf bank_mask:0xf
  v_and_b32_dpp v17, v25, v9 row_newbcast:15 row_mask:0xf bank_mask:0xf
  v_and_b32_dpp v18, v25, v10 row_newbcast:15 row_mask:0xf bank_mask:0xf
  v_and_b32_dpp v19, v25, v11 row_newbcast:15 row_mask:0xf bank_mask:0xf
  v_mfma_f32_16x16x32_bf16 v[20:23], v[12:15], v[184:187], v[20:23]
  s_nop 0
  v_mfma_f32_16x16x32_bf16 v[20:23], v[16:19], v[188:191], v[20:23]
  s_mov_b32 exec_hi, 0
  s_nop 6
  buffer_atomic_add_f32 v20, v55, s[72:75], s91 offen offset:0
  buffer_atomic_add_f32 v21, v55, s[72:75], s91 offen offset:128
  buffer_atomic_add_f32 v22, v55, s[72:75], s91 offen offset:256
  buffer_atomic_add_f32 v23, v55, s[72:75], s91 offen offset:384
  s_mov_b64 exec, -1
  s_mov_b32 s88, 1
  s_waitcnt vmcnt(0)
  s_atomic_add s88, s[40:41], s85 glc
  s_waitcnt lgkmcnt(0)
  s_cmp_lg_u32 s88, 31
  s_cbranch_scc1 L_hend
  buffer_load_dword v20, v55, s[72:75], s91 offen offset:0 sc1
  buffer_load_dword v21, v55, s[72:75], s91 offen offset:128 sc1
  buffer_load_dword v22, v55, s[72:75], s91 offen offset:256 sc1
  buffer_load_dword v23, v55, s[72:75], s91 offen offset:384 sc1
  buffer_load_dwordx4 v[36:39], v35, s[72:75], s86 offen sc1
  s_waitcnt vmcnt(0)
  v_cvt_pk_bf16_f32 v24, v20, v21
  v_cvt_pk_bf16_f32 v25, v22, v23
  v_lshlrev_b32 v20, 16, v24
  v_and_b32 v21, 0xffff0000, v24
  v_lshlrev_b32 v22, 16, v25
  v_and_b32 v23, 0xffff0000, v25
  v_add_f32 v20, v20, v4
  v_add_f32 v21, v21, v5
  v_add_f32 v22, v22, v6
  v_add_f32 v23, v23, v7
  v_cvt_pk_bf16_f32 v24, v20, v21
  v_cvt_pk_bf16_f32 v25, v22, v23
  v_lshlrev_b32 v20, 16, v24
  v_and_b32 v21, 0xffff0000, v24
  v_lshlrev_b32 v22, 16, v25
  v_and_b32 v23, 0xffff0000, v25
  v_add_f32 v20, v20, v36
  v_add_f32 v21, v21, v37
  v_add_f32 v22, v22, v38
  v_add_f32 v23, v23, v39
  v_cvt_pk_bf16_f32 v24, v20, v21
  v_cvt_pk_bf16_f32 v25, v22, v23
  s_mov_b32 exec_hi, 0
  buffer_store_dwordx2 v[24:25], v51, s[76:79], 0 offen
  s_mov_b64 exec, -1
L_hend:
L_end:
  s_endpgm
.section .rodata,"a"
.p2align 6
.amdhsa_kernel parallel_sum__mha_block_cached__dense_activation_gelu__decode_kernel
  .amdhsa_next_free_vgpr 256
  .amdhsa_next_free_sgpr 102
  .amdhsa_accum_offset 256
  .amdhsa_group_segment_fixed_size 0
  .amdhsa_kernarg_size 104
  .amdhsa_user_sgpr_count 2
  .amdhsa_user_sgpr_kernarg_segment_ptr 1
  .amdhsa_system_sgpr_workgroup_id_x 1
  .amdhsa_float_denorm_mode_32 3
.end_amdhsa_kernel
```
